```python
import torch

def _softmax(x, axis=-1):
    return torch.softmax(x, dim=axis)

def _gelu(x):
    return torch.nn.functional.gelu(x, approximate='tanh')

def _silu(x):
    return torch.nn.functional.silu(x)

def _sigmoid(x):
    return torch.sigmoid(x)

def _layernorm(x, axis=-1, eps=1e-05):
    m = x.mean(dim=axis, keepdim=True)
    v = x.var(dim=axis, keepdim=True, unbiased=False)
    return (x - m) / torch.sqrt(v + eps)

def _scatter_add(tgt, idx, src, axis=0):
    return tgt.clone().index_add_(axis, idx, src)

def _segment_sum(src, seg, n):
    out = torch.zeros((n,) + src.shape[1:], dtype=src.dtype)
    return out.index_add_(0, seg, src)

def _pad(x, pw):
    flat = tuple((v for pair in reversed(pw) for v in pair))
    return torch.nn.functional.pad(x, flat)
kernel_name = 'adaLN_cond__ssm_conv_h3__dense_activation_silu__prompt'

def setup_inputs():

    _w = lambda a: (lambda t: t.to(torch.bfloat16) if t.is_floating_point() else t)(torch.as_tensor(a))

    def _A_setup():
        B, S, D = (1, 2048, 1024)
        ks = 4
        return {'q': _w((lambda *s: torch.randn(*s, dtype=torch.bfloat16) * 0.05)(B, S, D)), 'k': _w((lambda *s: torch.randn(*s, dtype=torch.bfloat16) * 0.8)(B, S, D)), 'v': _w((lambda *s: torch.randn(*s, dtype=torch.bfloat16) * 0.8)(B, S, D)), 'shift_k': _w((lambda *s: torch.randn(*s, dtype=torch.bfloat16) * 0.8)(D, ks) * 0.5), 'ssm_k': _w((lambda *s: torch.randn(*s, dtype=torch.bfloat16) * 0.8)(D, S) * (1.0 / S ** 0.5)), 'ssm_D': _w((lambda *s: torch.randn(*s, dtype=torch.bfloat16) * 0.8)(D))}
    _A_in = _A_setup()

    def _B_setup():
        B, S, D, F = (1, 2048, 1024, 3584)
        return {'x': _w((lambda *s: torch.randn(*s, dtype=torch.bfloat16) * 0.05)(B, S, D)), 'w1': _w((lambda *s: torch.randn(*s, dtype=torch.bfloat16) * 3.2)(D, F) * D ** (-0.5)), 'w2': _w((lambda *s: torch.randn(*s, dtype=torch.bfloat16) * 1.6)(F, D) * F ** (-0.5))}
    _B_in = _B_setup()
    return {'A_q': _A_in['q'], 'A_k': _A_in['k'], 'A_v': _A_in['v'], 'A_shift_k': _A_in['shift_k'], 'A_ssm_k': _A_in['ssm_k'], 'A_ssm_D': _A_in['ssm_D'], 'B_x': _B_in['x'], 'B_w1': _B_in['w1'], 'B_w2': _B_in['w2'], 'c': _w((lambda *s: torch.randn(*s, dtype=torch.bfloat16) * 0.1)(1, 1024) * 8.0), 'w_mod': _w((lambda *s: torch.randn(*s, dtype=torch.bfloat16) * 0.1)(1024, 6 * 1024) * 1024 ** (-0.5) * 8.0)}

def reference(A_q, A_k, A_v, A_shift_k, A_ssm_k, A_ssm_D, B_x, B_w1, B_w2, c, w_mod):

    def _A_ref(q, k, v, shift_k, ssm_k, ssm_D):
        B, S, D = q.shape
        ks = shift_k.shape[-1]
        k_pad = _pad(k, ((0, 0), (ks - 1, 0), (0, 0)))
        k_shift = torch.zeros_like(k)
        for t in range(ks):
            k_shift = k_shift + k_pad[:, t:t + S, :] * shift_k[:, ks - 1 - t][None, None, :]
        kv = k_shift * v
        L = 2 * S
        kv_pad = _pad(kv, ((0, 0), (0, S), (0, 0)))
        kf_pad = _pad(ssm_k, ((0, 0), (0, S)))
        kv_f = (lambda x, axes=(-2, -1): torch.fft.rfft2(x.float(), dim=axes))(kv_pad[:, None, :, :], axes=(1, 2))
        kf_f = (lambda x, axes=(-2, -1): torch.fft.rfft2(x.float(), dim=axes))(kf_pad[:, None, :], axes=(1, 2))
        kf_f = (lambda x, *d: x.permute(*d))(kf_f, 1, 2, 0)
        y_f = kv_f * kf_f[None, :, :, :]
        y = (lambda x, s, axes=(-2, -1): torch.fft.irfft2(x, s=s, dim=axes).to(torch.bfloat16))(y_f, (1, L), axes=(1, 2))[:, 0, :S, :]
        y = y + kv * ssm_D[None, None, :]
        return q * y

    def _B_ref(x, w1, w2):
        h = torch.einsum('bsd,df->bsf', x, w1)
        h = _silu(h)
        out = torch.einsum('bsf,fd->bsd', h, w2)
        return out
    x = A_q
    mod = (_silu(c) @ w_mod).reshape(c.shape[0], 6, 1, -1)
    sa, ca, ga, sb, cb, gb = (mod[:, 0].clone(), mod[:, 1].clone(), mod[:, 2].clone(), mod[:, 3].clone(), mod[:, 4].clone(), mod[:, 5].clone())
    h = _layernorm(x, axis=-1) * (1 + ca) + sa
    x = x + ga * _A_ref(h, A_k, A_v, A_shift_k, A_ssm_k, A_ssm_D)
    h = _layernorm(x, axis=-1) * (1 + cb) + sb
    x = x + gb * _B_ref(h, B_w1, B_w2)
    return x
```

```asm
; @launch kernel=f1_kernel grid=(256,1,1) block=(512,1,1) lds=163840
.amdgcn_target "amdgcn-amd-amdhsa--gfx950"
.text
.globl f1_kernel
.p2align 8
.type f1_kernel,@function
f1_kernel:
    s_cmp_ge_u32 s2, 256
    s_cbranch_scc1 f1_kernel_done
    s_load_dwordx4 s[96:99], s[0:1], 8
    s_load_dwordx2 s[100:101], s[0:1], 24
    s_load_dwordx16 s[64:79], s[0:1], 32
    s_load_dwordx2 s[4:5], s[0:1], 104
    s_load_dwordx2 s[6:7], s[0:1], 0
    s_cmp_ge_u32 s2, 16
    s_cbranch_scc1 f1_kernel_nc
    s_getpc_b64 s[8:9]
f1_kernel_pc:
    s_mov_b32 s10, code_end-f1_kernel_pc
    s_mov_b32 s11, 0x20000
    v_lshlrev_b32 v13, 7, v0
    buffer_load_dword v216, v13, s[8:11], 0 offen
f1_kernel_nc:
    v_mov_b32 v14, 161792
    v_mov_b32 v4, 0
    v_mov_b32 v5, 0
    ds_write_b64 v14, v[4:5] offset:0
    ds_write_b64 v14, v[4:5] offset:8
    ds_write_b64 v14, v[4:5] offset:16
    ds_write_b64 v14, v[4:5] offset:24
    ds_write_b64 v14, v[4:5] offset:32
    ds_write_b64 v14, v[4:5] offset:40
    v_lshrrev_b32 v1, 6, v0
    v_and_b32 v2, 63, v0
    v_readfirstlane_b32 s20, v1
    s_and_b32 s21, s2, 7
    s_lshl_b32 s21, s21, 1
    s_bfe_u32 s22, s2, 0x10003
    s_add_u32 s21, s21, s22
    s_lshr_b32 s22, s2, 4
    v_and_b32 v1, 15, v0
    v_lshrrev_b32 v9, 4, v0
    s_lshl_b32 s23, s22, 18
    s_lshl_b32 s24, s21, 7
    s_add_u32 s23, s23, s24
    s_sub_u32 s23, s23, 6144
    v_lshlrev_b32 v3, 13, v9
    v_lshl_add_u32 v3, v1, 3, v3
    v_add_u32 v3, s23, v3
    v_add_u32 v4, 4096, v3
    v_add_u32 v5, 6144, v3
    v_add_u32 v6, 10240, v3
    s_lshl_b32 s24, s21, 9
    v_lshlrev_b32 v7, 5, v1
    s_waitcnt lgkmcnt(0)
    s_mov_b32 s12, s96
    s_mov_b32 s13, s97
    s_mov_b32 s14, 0x400000
    s_mov_b32 s15, 0x20000
    s_mov_b32 s16, s98
    s_mov_b32 s17, s99
    s_mov_b32 s18, 0x400000
    s_mov_b32 s19, 0x20000
    buffer_load_dwordx2 v[22:23], v5, s[12:15], 0 offen offset:0 nt
    buffer_load_dwordx2 v[24:25], v5, s[12:15], 0 offen offset:2048 nt
    buffer_load_dwordx2 v[26:27], v6, s[12:15], 0 offen offset:0 nt
    buffer_load_dwordx2 v[28:29], v6, s[12:15], 0 offen offset:2048 nt
    buffer_load_dwordx2 v[32:33], v5, s[16:19], 0 offen offset:0 nt
    buffer_load_dwordx2 v[34:35], v5, s[16:19], 0 offen offset:2048 nt
    buffer_load_dwordx2 v[36:37], v6, s[16:19], 0 offen offset:0 nt
    buffer_load_dwordx2 v[38:39], v6, s[16:19], 0 offen offset:2048 nt
    s_mov_b64 exec, 0xffff
    buffer_load_dwordx2 v[16:17], v3, s[12:15], 0 offen offset:0 nt
    buffer_load_dwordx2 v[18:19], v3, s[12:15], 0 offen offset:2048 nt
    buffer_load_dwordx2 v[20:21], v4, s[12:15], 0 offen offset:0 nt
    s_mov_b64 exec, -1
    s_mov_b32 s28, s100
    s_mov_b32 s29, s101
    s_mov_b32 s30, 0x2000
    s_mov_b32 s31, 0x20000
    buffer_load_dwordx4 v[40:43], v7, s[28:31], s24 offen
    buffer_load_dwordx4 v[44:47], v7, s[28:31], s24 offen offset:16
    s_add_u32 s56, s4, 0x2200000
    s_addc_u32 s57, s5, 0
    s_mov_b32 s58, 0x80000
    s_mov_b32 s59, 0x20000
    s_load_dword s83, s[56:57], 458804
    v_lshlrev_b32 v3, 4, v2
    s_and_b32 s62, s2, 7
    s_lshl_b32 s62, s62, 5
    s_lshr_b32 s63, s2, 3
    s_add_u32 s62, s62, s63
    s_mov_b32 s32, s4
    s_mov_b32 s33, s5
    s_mov_b32 s34, 0x400000
    s_mov_b32 s35, 0x20000
    v_lshrrev_b32 v8, 1, v9
    v_and_b32 v10, 7, v1
    v_xor_b32 v8, v8, v10
    v_lshlrev_b32 v8, 4, v8
    v_lshl_add_u32 v8, v1, 10, v8
    v_and_b32 v10, 1, v9
    v_xor_b32 v10, 1, v10
    v_lshl_add_u32 v8, v10, 3, v8
    v_add_u32 v8, 135168, v8
    v_lshrrev_b32 v10, 6, v0
    v_xor_b32 v10, v10, v1
    v_lshlrev_b32 v10, 4, v10
    v_lshl_add_u32 v10, v9, 8, v10
    v_add_u32 v10, 135168, v10
    v_lshlrev_b32 v11, 4, v1
    v_lshl_add_u32 v11, v9, 12, v11
    s_lshl_b32 s25, s21, 18
    s_lshl_b32 s26, s22, 8
    s_add_u32 s25, s25, s26
    s_add_u32 s26, s25, 0x20000
    s_mov_b32 s27, 0xffff0000
    s_lshl_b32 s23, s21, 4
    s_add_u32 s23, s23, s22
    s_lshl_b32 s23, s23, 10
    s_lshr_b32 s39, s23, 3
    s_add_u32 s39, s39, 327680
    s_lshl_b32 s61, s62, 3
    s_add_u32 s61, s61, s20
    s_lshl_b32 s61, s61, 11
    v_subrev_u32 v12, 16, v2
    v_lshlrev_b32 v12, 2, v12
    s_cmp_ge_u32 s20, 4
    s_cbranch_scc1 f1_kernel_noh
    s_lshl_b32 s63, s62, 2
    s_add_u32 s63, s63, s20
    s_lshr_b32 s60, s63, 1
    s_lshl_b32 s60, s60, 2
    s_load_dword s82, s[66:67], s60
    v_mov_b32 v204, 0
    v_mov_b32 v205, 0
    s_waitcnt vmcnt(0)
    s_lshl_b32 s60, s63, 12
    s_mov_b32 s8, s64
    s_mov_b32 s9, s65
    s_mov_b32 s10, 0x400000
    s_mov_b32 s11, 0x20000
    buffer_load_dwordx4 v[216:219], v3, s[8:11], s60 offen offset:0 nt
    buffer_load_dwordx4 v[220:223], v3, s[8:11], s60 offen offset:1024 nt
    buffer_load_dwordx4 v[224:227], v3, s[8:11], s60 offen offset:2048 nt
    buffer_load_dwordx4 v[228:231], v3, s[8:11], s60 offen offset:3072 nt
    s_branch f1_kernel_h1
f1_kernel_noh:
    s_sub_u32 s63, s20, 4
    s_lshr_b32 s36, s2, 1
    s_and_b32 s37, s2, 1
    s_lshl_b32 s37, s37, 2
    s_add_u32 s37, s37, s63
    v_and_b32 v4, 7, v2
    v_lshrrev_b32 v5, 3, v2
    s_mov_b32 s80, 196608
    v_mul_lo_u32 v204, v5, s80
    v_lshl_add_u32 v204, v4, 4, v204
    v_lshlrev_b32 v205, 5, v5
    s_mul_i32 s80, s37, 1572864
    s_lshl_b32 s81, s36, 7
    s_add_u32 s80, s80, s81
    s_lshl_b32 s37, s37, 8
    s_mov_b32 s12, s76
    s_mov_b32 s13, s77
    s_mov_b32 s14, 0xc00000
    s_mov_b32 s15, 0x20000
    s_mov_b32 s28, s74
    s_mov_b32 s29, s75
    s_mov_b32 s30, 0x800
    s_mov_b32 s31, 0x20000
    s_cmp_ge_u32 s2, 192
    s_cselect_b32 s14, 0, s14
    s_waitcnt vmcnt(0)
    buffer_load_dwordx4 v[104:107], v204, s[12:15], s80 offen nt
    s_add_u32 s80, s80, 12288
    buffer_load_dwordx4 v[108:111], v204, s[12:15], s80 offen nt
    s_add_u32 s80, s80, 12288
f1_kernel_h1:
    ds_bpermute_b32 v96, v12, v24
    ds_bpermute_b32 v97, v12, v25
    ds_bpermute_b32 v98, v12, v26
    ds_bpermute_b32 v99, v12, v27
    ds_bpermute_b32 v100, v12, v28
    ds_bpermute_b32 v101, v12, v29
    v_cmp_gt_u32 vcc, 16, v2
    v_lshlrev_b32 v48, 16, v40
    v_and_b32 v50, s27, v40
    v_lshlrev_b32 v52, 16, v41
    v_and_b32 v54, s27, v41
    v_lshlrev_b32 v49, 16, v42
    v_and_b32 v51, s27, v42
    v_lshlrev_b32 v53, 16, v43
    v_and_b32 v55, s27, v43
    v_lshlrev_b32 v56, 16, v44
    v_and_b32 v58, s27, v44
    v_lshlrev_b32 v60, 16, v45
    v_and_b32 v62, s27, v45
    v_lshlrev_b32 v57, 16, v46
    v_and_b32 v59, s27, v46
    v_lshlrev_b32 v61, 16, v47
    v_and_b32 v63, s27, v47
    s_waitcnt lgkmcnt(0)
    v_cndmask_b32 v16, v96, v16, vcc
    v_cndmask_b32 v17, v97, v17, vcc
    v_cndmask_b32 v18, v98, v18, vcc
    v_cndmask_b32 v19, v99, v19, vcc
    v_cndmask_b32 v20, v100, v20, vcc
    v_cndmask_b32 v21, v101, v21, vcc
    v_lshlrev_b32 v64, 16, v16
    v_and_b32 v65, s27, v16
    v_lshlrev_b32 v66, 16, v18
    v_and_b32 v67, s27, v18
    v_lshlrev_b32 v68, 16, v20
    v_and_b32 v69, s27, v20
    v_lshlrev_b32 v70, 16, v22
    v_and_b32 v71, s27, v22
    v_lshlrev_b32 v72, 16, v24
    v_and_b32 v73, s27, v24
    v_lshlrev_b32 v74, 16, v26
    v_and_b32 v75, s27, v26
    v_lshlrev_b32 v76, 16, v28
    v_and_b32 v77, s27, v28
    v_lshlrev_b32 v80, 16, v32
    v_and_b32 v81, s27, v32
    v_lshlrev_b32 v82, 16, v34
    v_and_b32 v83, s27, v34
    v_lshlrev_b32 v84, 16, v36
    v_and_b32 v85, s27, v36
    v_lshlrev_b32 v86, 16, v38
    v_and_b32 v87, s27, v38
    v_pk_mul_f32 v[88:89], v[64:65], v[54:55]
    v_pk_mul_f32 v[90:91], v[66:67], v[54:55]
    v_pk_mul_f32 v[92:93], v[68:69], v[54:55]
    v_pk_mul_f32 v[94:95], v[70:71], v[54:55]
    v_pk_fma_f32 v[88:89], v[66:67], v[52:53], v[88:89]
    v_pk_fma_f32 v[90:91], v[68:69], v[52:53], v[90:91]
    v_pk_fma_f32 v[92:93], v[70:71], v[52:53], v[92:93]
    v_pk_fma_f32 v[94:95], v[72:73], v[52:53], v[94:95]
    v_pk_fma_f32 v[88:89], v[68:69], v[50:51], v[88:89]
    v_pk_fma_f32 v[90:91], v[70:71], v[50:51], v[90:91]
    v_pk_fma_f32 v[92:93], v[72:73], v[50:51], v[92:93]
    v_pk_fma_f32 v[94:95], v[74:75], v[50:51], v[94:95]
    v_pk_fma_f32 v[88:89], v[70:71], v[48:49], v[88:89]
    v_pk_fma_f32 v[90:91], v[72:73], v[48:49], v[90:91]
    v_pk_fma_f32 v[92:93], v[74:75], v[48:49], v[92:93]
    v_pk_fma_f32 v[94:95], v[76:77], v[48:49], v[94:95]
    v_pk_mul_f32 v[88:89], v[88:89], v[80:81]
    v_pk_mul_f32 v[90:91], v[90:91], v[82:83]
    v_pk_mul_f32 v[92:93], v[92:93], v[84:85]
    v_pk_mul_f32 v[94:95], v[94:95], v[86:87]
    v_cvt_pk_bf16_f32 v96, v94, v92
    v_cvt_pk_bf16_f32 v97, v90, v88
    ds_write_b64 v8, v[96:97] offset:0
    v_cvt_pk_bf16_f32 v98, v95, v93
    v_cvt_pk_bf16_f32 v99, v91, v89
    ds_write_b64 v8, v[98:99] offset:256
    v_lshlrev_b32 v64, 16, v17
    v_and_b32 v65, s27, v17
    v_lshlrev_b32 v66, 16, v19
    v_and_b32 v67, s27, v19
    v_lshlrev_b32 v68, 16, v21
    v_and_b32 v69, s27, v21
    v_lshlrev_b32 v70, 16, v23
    v_and_b32 v71, s27, v23
    v_lshlrev_b32 v72, 16, v25
    v_and_b32 v73, s27, v25
    v_lshlrev_b32 v74, 16, v27
    v_and_b32 v75, s27, v27
    v_lshlrev_b32 v76, 16, v29
    v_and_b32 v77, s27, v29
    v_lshlrev_b32 v80, 16, v33
    v_and_b32 v81, s27, v33
    v_lshlrev_b32 v82, 16, v35
    v_and_b32 v83, s27, v35
    v_lshlrev_b32 v84, 16, v37
    v_and_b32 v85, s27, v37
    v_lshlrev_b32 v86, 16, v39
    v_and_b32 v87, s27, v39
    v_pk_mul_f32 v[88:89], v[64:65], v[62:63]
    v_pk_mul_f32 v[90:91], v[66:67], v[62:63]
    v_pk_mul_f32 v[92:93], v[68:69], v[62:63]
    v_pk_mul_f32 v[94:95], v[70:71], v[62:63]
    v_pk_fma_f32 v[88:89], v[66:67], v[60:61], v[88:89]
    v_pk_fma_f32 v[90:91], v[68:69], v[60:61], v[90:91]
    v_pk_fma_f32 v[92:93], v[70:71], v[60:61], v[92:93]
    v_pk_fma_f32 v[94:95], v[72:73], v[60:61], v[94:95]
    v_pk_fma_f32 v[88:89], v[68:69], v[58:59], v[88:89]
    v_pk_fma_f32 v[90:91], v[70:71], v[58:59], v[90:91]
    v_pk_fma_f32 v[92:93], v[72:73], v[58:59], v[92:93]
    v_pk_fma_f32 v[94:95], v[74:75], v[58:59], v[94:95]
    v_pk_fma_f32 v[88:89], v[70:71], v[56:57], v[88:89]
    v_pk_fma_f32 v[90:91], v[72:73], v[56:57], v[90:91]
    v_pk_fma_f32 v[92:93], v[74:75], v[56:57], v[92:93]
    v_pk_fma_f32 v[94:95], v[76:77], v[56:57], v[94:95]
    v_pk_mul_f32 v[88:89], v[88:89], v[80:81]
    v_pk_mul_f32 v[90:91], v[90:91], v[82:83]
    v_pk_mul_f32 v[92:93], v[92:93], v[84:85]
    v_pk_mul_f32 v[94:95], v[94:95], v[86:87]
    v_cvt_pk_bf16_f32 v100, v94, v92
    v_cvt_pk_bf16_f32 v101, v90, v88
    ds_write_b64 v8, v[100:101] offset:512
    v_cvt_pk_bf16_f32 v102, v95, v93
    v_cvt_pk_bf16_f32 v103, v91, v89
    ds_write_b64 v8, v[102:103] offset:768
    s_waitcnt lgkmcnt(0)
    s_barrier
    ds_read_b128 v[16:19], v10
    ds_read_b128 v[20:23], v10 offset:8192
    s_mul_i32 s83, s83, 0x9e3779b1
    s_add_u32 s83, s83, 0x7f4a7c15
    s_mov_b32 s21, s62
    s_waitcnt lgkmcnt(1)
    buffer_store_dwordx4 v[16:19], v11, s[32:35], s25 offen sc0 sc1
    s_waitcnt lgkmcnt(0)
    buffer_store_dwordx4 v[20:23], v11, s[32:35], s26 offen sc0 sc1
    v_mov_b32 v12, 0
    v_mov_b32 v13, s83
f1_kernel_p0end:
    s_cmp_ge_u32 s20, 4
    s_cbranch_scc1 f1_kernel_L
    s_mov_b32 s22, s63
    s_mul_i32 s62, s20, 24320
    s_lshl_b32 s24, s22, 12
    v_mov_b32 v32, 0
    v_mov_b32 v33, 0
    v_mov_b32 v34, 0
    v_mov_b32 v35, 0
    v_add_u32 v4, s62, v3
    ds_write_b128 v4, v[32:35] offset:16640
    v_min_u32 v5, 25, v2
    v_lshlrev_b32 v5, 4, v5
    v_add_u32 v5, s62, v5
    ds_write_b128 v5, v[32:35] offset:17664
    v_and_b32 v6, 15, v2
    v_lshrrev_b32 v7, 4, v2
    v_and_b32 v8, 3, v6
    v_mul_u32_u24 v8, 4160, v8
    v_lshl_add_u32 v5, v7, 4, v8
    v_add_u32 v5, s62, v5
    ds_write_b128 v5, v[32:35]
    v_lshrrev_b32 v5, 2, v2
    v_mul_u32_u24 v5, 96, v5
    v_and_b32 v9, 3, v2
    v_lshl_add_u32 v5, v9, 4, v5
    v_add_u32 v5, s62, v5
    v_lshrrev_b32 v9, 2, v6
    v_lshlrev_b32 v10, 1, v7
    v_sub_u32 v9, v9, v10
    v_add_u32 v9, 7, v9
    v_lshl_add_u32 v8, v9, 3, v8
    v_add_u32 v8, s62, v8
    v_mul_u32_u24 v9, 96, v6
    v_lshl_add_u32 v9, v7, 4, v9
    s_add_u32 s25, s62, 17984
    v_add_u32 v9, s25, v9
    v_mov_b32 v48, 0
    v_mov_b32 v49, 0
    v_mov_b32 v50, 0
    v_mov_b32 v51, 0
    v_mov_b32 v52, 0
    v_mov_b32 v53, 0
    v_mov_b32 v54, 0
    v_mov_b32 v55, 0
    v_mov_b32 v56, 0
    v_mov_b32 v57, 0
    v_mov_b32 v58, 0
    v_mov_b32 v59, 0
    v_mov_b32 v60, 0
    v_mov_b32 v61, 0
    v_mov_b32 v62, 0
    v_mov_b32 v63, 0
    v_mov_b32 v64, 0
    v_mov_b32 v65, 0
    v_mov_b32 v66, 0
    v_mov_b32 v67, 0
    v_mov_b32 v68, 0
    v_mov_b32 v69, 0
    v_mov_b32 v70, 0
    v_mov_b32 v71, 0
    v_mov_b32 v72, 0
    v_mov_b32 v73, 0
    v_mov_b32 v74, 0
    v_mov_b32 v75, 0
    v_mov_b32 v76, 0
    v_mov_b32 v77, 0
    v_mov_b32 v78, 0
    v_mov_b32 v79, 0
    v_lshlrev_b32 v10, 3, v7
    v_add_u32 v10, 7, v10
    v_sub_u32 v10, v10, v6
    v_and_b32 v11, 1, v10
    v_lshlrev_b32 v11, 4, v11
    v_ashrrev_i32 v10, 1, v10
    s_and_b32 s25, s22, 1
    s_lshl_b32 s25, s25, 4
    s_lshr_b32 s82, s82, s25
    s_and_b32 s82, s82, 0xffff
    v_lshlrev_b32 v11, v11, s82
    v_cmp_eq_u32 s[8:9], 0, v10
    v_cmp_eq_u32 s[10:11], 1, v10
    v_cmp_eq_u32 s[12:13], 2, v10
    v_cmp_eq_u32 s[14:15], 3, v10
    v_cndmask_b32 v36, 0, v11, s[8:9]
    v_cndmask_b32 v37, 0, v11, s[10:11]
    v_cndmask_b32 v38, 0, v11, s[12:13]
    v_cndmask_b32 v39, 0, v11, s[14:15]
    v_cmp_eq_u32 s[8:9], 8, v10
    v_cmp_eq_u32 s[10:11], 9, v10
    v_cmp_eq_u32 s[12:13], 10, v10
    v_cmp_eq_u32 s[14:15], 11, v10
    v_cndmask_b32 v40, 0, v11, s[8:9]
    v_cndmask_b32 v41, 0, v11, s[10:11]
    v_cndmask_b32 v42, 0, v11, s[12:13]
    v_cndmask_b32 v43, 0, v11, s[14:15]
    v_mov_b32 v15, 1
    s_waitcnt vmcnt(0)
    s_mov_b64 exec, 1
    ds_add_rtn_u32 v15, v14, v15 offset:16
    s_waitcnt lgkmcnt(0)
    v_cmp_eq_u32 vcc, 7, v15
    v_mov_b32 v15, s83
    s_nop 0
    s_cbranch_vccz f1_kernel_ak
    buffer_store_dword v15, off, s[56:59], s39
    buffer_store_dword v15, off, s[56:59], s23 offset:768 sc0 sc1
f1_kernel_ak:
    s_mov_b64 exec, -1
    s_waitcnt vmcnt(3)
    v_mov_b32 v96, 0
    v_mov_b32 v97, 0
    ds_write_b128 v4, v[216:219] offset:12544
    v_mov_b32_dpp v96, v218 wave_shr:1 row_mask:0xf bank_mask:0xf
    v_mov_b32_dpp v97, v219 wave_shr:1 row_mask:0xf bank_mask:0xf
    v_alignbit_b32 v105, v217, v216, 16
    v_alignbit_b32 v106, v218, v217, 16
    v_alignbit_b32 v107, v219, v218, 16
    v_alignbit_b32 v104, v216, v97, 16
    ds_write_b128 v4, v[104:107] offset:8384
    v_mov_b32 v100, v97
    v_mov_b32 v101, v216
    v_mov_b32 v102, v217
    v_mov_b32 v103, v218
    ds_write_b128 v4, v[100:103] offset:4224
    v_alignbit_b32 v108, v97, v96, 16
    v_mov_b32 v109, v104
    v_mov_b32 v110, v105
    v_mov_b32 v111, v106
    ds_write_b128 v4, v[108:111] offset:64
    s_waitcnt vmcnt(2)
    v_mov_b32_dpp v98, v218 wave_ror:1 row_mask:0xf bank_mask:0xf
    v_mov_b32_dpp v99, v219 wave_ror:1 row_mask:0xf bank_mask:0xf
    ds_write_b128 v4, v[220:223] offset:13568
    v_mov_b32_dpp v98, v222 wave_shr:1 row_mask:0xf bank_mask:0xf
    v_mov_b32_dpp v99, v223 wave_shr:1 row_mask:0xf bank_mask:0xf
    v_alignbit_b32 v117, v221, v220, 16
    v_alignbit_b32 v118, v222, v221, 16
    v_alignbit_b32 v119, v223, v222, 16
    v_alignbit_b32 v116, v220, v99, 16
    ds_write_b128 v4, v[116:119] offset:9408
    v_mov_b32 v112, v99
    v_mov_b32 v113, v220
    v_mov_b32 v114, v221
    v_mov_b32 v115, v222
    ds_write_b128 v4, v[112:115] offset:5248
    v_alignbit_b32 v120, v99, v98, 16
    v_mov_b32 v121, v116
    v_mov_b32 v122, v117
    v_mov_b32 v123, v118
    ds_write_b128 v4, v[120:123] offset:1088
    s_waitcnt vmcnt(1)
    v_mov_b32_dpp v96, v222 wave_ror:1 row_mask:0xf bank_mask:0xf
    v_mov_b32_dpp v97, v223 wave_ror:1 row_mask:0xf bank_mask:0xf
    ds_write_b128 v4, v[224:227] offset:14592
    v_mov_b32_dpp v96, v226 wave_shr:1 row_mask:0xf bank_mask:0xf
    v_mov_b32_dpp v97, v227 wave_shr:1 row_mask:0xf bank_mask:0xf
    v_alignbit_b32 v105, v225, v224, 16
    v_alignbit_b32 v106, v226, v225, 16
    v_alignbit_b32 v107, v227, v226, 16
    v_alignbit_b32 v104, v224, v97, 16
    ds_write_b128 v4, v[104:107] offset:10432
    v_mov_b32 v100, v97
    v_mov_b32 v101, v224
    v_mov_b32 v102, v225
    v_mov_b32 v103, v226
    ds_write_b128 v4, v[100:103] offset:6272
    v_alignbit_b32 v108, v97, v96, 16
    v_mov_b32 v109, v104
    v_mov_b32 v110, v105
    v_mov_b32 v111, v106
    ds_write_b128 v4, v[108:111] offset:2112
    s_waitcnt vmcnt(0)
    v_mov_b32_dpp v98, v226 wave_ror:1 row_mask:0xf bank_mask:0xf
    v_mov_b32_dpp v99, v227 wave_ror:1 row_mask:0xf bank_mask:0xf
    ds_write_b128 v4, v[228:231] offset:15616
    v_mov_b32_dpp v98, v230 wave_shr:1 row_mask:0xf bank_mask:0xf
    v_mov_b32_dpp v99, v231 wave_shr:1 row_mask:0xf bank_mask:0xf
    v_alignbit_b32 v117, v229, v228, 16
    v_alignbit_b32 v118, v230, v229, 16
    v_alignbit_b32 v119, v231, v230, 16
    v_alignbit_b32 v116, v228, v99, 16
    ds_write_b128 v4, v[116:119] offset:11456
    v_mov_b32 v112, v99
    v_mov_b32 v113, v228
    v_mov_b32 v114, v229
    v_mov_b32 v115, v230
    ds_write_b128 v4, v[112:115] offset:7296
    v_alignbit_b32 v120, v99, v98, 16
    v_mov_b32 v121, v116
    v_mov_b32 v122, v117
    v_mov_b32 v123, v118
    ds_write_b128 v4, v[120:123] offset:3136
    s_lshr_b32 s25, s21, 4
    s_lshl_b32 s25, s25, 14
    s_add_u32 s25, s25, 768
    v_lshlrev_b32 v10, 10, v6
    v_add_u32 v10, s25, v10
    s_mov_b32 s28, s4
    s_mov_b32 s29, s5
    s_mov_b32 s30, 0x400000
    s_mov_b32 s31, 0x20000
    s_lshr_b32 s25, s21, 4
    s_lshl_b32 s25, s25, 11
    s_add_u32 s25, s25, 327680
    v_lshlrev_b32 v11, 7, v6
    v_add_u32 v11, s25, v11
    s_mov_b32 s60, 0x40000
    s_branch f1_kernel_pk_in
f1_kernel_pk:
    s_sleep 1
f1_kernel_pk_in:
    buffer_load_dword v12, v11, s[56:59], 0 offen sc0 sc1
    s_sub_u32 s60, s60, 1
    s_cmp_eq_u32 s60, 0
    s_cbranch_scc1 f1_kernel_pk_out
    s_waitcnt vmcnt(0)
    v_cmp_ne_u32 vcc, s83, v12
    s_nop 1
    s_cbranch_vccz f1_kernel_pk_out
    s_and_b32 s10, s60, 3
    s_cbranch_scc1 f1_kernel_pk
    buffer_load_dword v13, v10, s[56:59], 0 offen sc0 sc1
    s_mov_b64 s[8:9], vcc
    s_waitcnt vmcnt(0)
    v_cmp_ne_u32 vcc, s83, v13
    s_nop 1
    s_and_b64 vcc, vcc, s[8:9]
    s_cbranch_scc1 f1_kernel_pk
f1_kernel_pk_out:
    buffer_load_dwordx4 v[16:19], v3, s[28:31], s24 offen offset:0 sc0 sc1
    buffer_load_dwordx4 v[20:23], v3, s[28:31], s24 offen offset:1024 sc0 sc1
    buffer_load_dwordx4 v[24:27], v3, s[28:31], s24 offen offset:2048 sc0 sc1
    buffer_load_dwordx4 v[28:31], v3, s[28:31], s24 offen offset:3072 sc0 sc1
    s_mov_b32 s8, s6
    s_mov_b32 s9, s7
    s_mov_b32 s10, 0x400000
    s_mov_b32 s11, 0x20000
    buffer_load_dwordx4 v[232:235], v3, s[8:11], s61 offen offset:0 nt
    buffer_load_dwordx4 v[236:239], v3, s[8:11], s61 offen offset:1024 nt
    v_mov_b32 v15, 1
    ds_add_u32 v14, v15 offset:8
    s_waitcnt vmcnt(5)
    ds_write_b128 v5, v[16:19] offset:18080
    s_waitcnt vmcnt(4)
    ds_write_b128 v5, v[20:23] offset:19616
    s_waitcnt vmcnt(3)
    ds_write_b128 v5, v[24:27] offset:21152
    s_waitcnt vmcnt(2)
    ds_write_b128 v5, v[28:31] offset:22688
    s_waitcnt lgkmcnt(0)
    ds_read_b64 v[80:81], v8 offset:0
    ds_read_b64 v[82:83], v8 offset:8
    ds_read_b64 v[84:85], v8 offset:32
    ds_read_b64 v[86:87], v8 offset:40
    ds_read_b128 v[112:115], v9 offset:96
    ds_read_b128 v[116:119], v9 offset:1632
    ds_read_b128 v[120:123], v9 offset:3168
    ds_read_b128 v[124:127], v9 offset:4704
    ds_read_b64 v[88:89], v8 offset:1024
    ds_read_b64 v[90:91], v8 offset:1032
    ds_read_b64 v[92:93], v8 offset:1056
    ds_read_b64 v[94:95], v8 offset:1064
    ds_read_b64 v[96:97], v8 offset:2048
    ds_read_b64 v[98:99], v8 offset:2056
    ds_read_b64 v[100:101], v8 offset:2080
    ds_read_b64 v[102:103], v8 offset:2088
    ds_read_b64 v[104:105], v8 offset:3072
    ds_read_b64 v[106:107], v8 offset:3080
    ds_read_b64 v[108:109], v8 offset:3104
    ds_read_b64 v[110:111], v8 offset:3112
    s_waitcnt lgkmcnt(12)
    v_mfma_f32_16x16x32_bf16 v[48:51], v[36:39], v[112:115], v[48:51]
    v_mfma_f32_16x16x32_bf16 v[52:55], v[40:43], v[112:115], v[52:55]
    v_mfma_f32_16x16x32_bf16 v[56:59], v[36:39], v[116:119], v[56:59]
    v_mfma_f32_16x16x32_bf16 v[60:63], v[40:43], v[116:119], v[60:63]
    v_mfma_f32_16x16x32_bf16 v[64:67], v[36:39], v[120:123], v[64:67]
    v_mfma_f32_16x16x32_bf16 v[68:71], v[40:43], v[120:123], v[68:71]
    v_mfma_f32_16x16x32_bf16 v[72:75], v[36:39], v[124:127], v[72:75]
    v_mfma_f32_16x16x32_bf16 v[76:79], v[40:43], v[124:127], v[76:79]
    s_mov_b32 s26, 4
.p2align 6
f1_kernel_cv0:
    s_waitcnt lgkmcnt(12)
    v_mfma_f32_16x16x32_bf16 v[48:51], v[80:83], v[112:115], v[48:51]
    ds_read_b64 v[128:129], v8 offset:64
    v_mfma_f32_16x16x32_bf16 v[52:55], v[84:87], v[112:115], v[52:55]
    ds_read_b64 v[130:131], v8 offset:72
    v_mfma_f32_16x16x32_bf16 v[56:59], v[80:83], v[116:119], v[56:59]
    ds_read_b64 v[132:133], v8 offset:96
    v_mfma_f32_16x16x32_bf16 v[60:63], v[84:87], v[116:119], v[60:63]
    ds_read_b64 v[134:135], v8 offset:104
    s_waitcnt lgkmcnt(1)
    v_mfma_f32_16x16x32_bf16 v[64:67], v[80:83], v[120:123], v[64:67]
    ds_read_b128 v[160:163], v9 offset:0
    v_mfma_f32_16x16x32_bf16 v[68:71], v[84:87], v[120:123], v[68:71]
    ds_read_b128 v[164:167], v9 offset:1536
    v_mfma_f32_16x16x32_bf16 v[72:75], v[80:83], v[124:127], v[72:75]
    ds_read_b128 v[168:171], v9 offset:3072
    v_mfma_f32_16x16x32_bf16 v[76:79], v[84:87], v[124:127], v[76:79]
    ds_read_b128 v[172:175], v9 offset:4608
    s_waitcnt lgkmcnt(1)
    s_waitcnt lgkmcnt(15)
    v_mfma_f32_16x16x32_bf16 v[56:59], v[88:91], v[112:115], v[56:59]
    ds_read_b64 v[136:137], v8 offset:1088
    v_mfma_f32_16x16x32_bf16 v[60:63], v[92:95], v[112:115], v[60:63]
    ds_read_b64 v[138:139], v8 offset:1096
    v_mfma_f32_16x16x32_bf16 v[64:67], v[88:91], v[116:119], v[64:67]
    ds_read_b64 v[140:141], v8 offset:1120
    v_mfma_f32_16x16x32_bf16 v[68:71], v[92:95], v[116:119], v[68:71]
    ds_read_b64 v[142:143], v8 offset:1128
    s_waitcnt lgkmcnt(1)
    v_mfma_f32_16x16x32_bf16 v[72:75], v[88:91], v[120:123], v[72:75]
    ds_read_b64 v[144:145], v8 offset:2112
    v_mfma_f32_16x16x32_bf16 v[76:79], v[92:95], v[120:123], v[76:79]
    ds_read_b64 v[146:147], v8 offset:2120
    s_waitcnt lgkmcnt(15)
    v_mfma_f32_16x16x32_bf16 v[64:67], v[96:99], v[112:115], v[64:67]
    ds_read_b64 v[148:149], v8 offset:2144
    v_mfma_f32_16x16x32_bf16 v[68:71], v[100:103], v[112:115], v[68:71]
    ds_read_b64 v[150:151], v8 offset:2152
    s_waitcnt lgkmcnt(1)
    v_mfma_f32_16x16x32_bf16 v[72:75], v[96:99], v[116:119], v[72:75]
    ds_read_b64 v[152:153], v8 offset:3136
    v_mfma_f32_16x16x32_bf16 v[76:79], v[100:103], v[116:119], v[76:79]
    ds_read_b64 v[154:155], v8 offset:3144
    s_waitcnt lgkmcnt(15)
    v_mfma_f32_16x16x32_bf16 v[72:75], v[104:107], v[112:115], v[72:75]
    ds_read_b64 v[156:157], v8 offset:3168
    v_mfma_f32_16x16x32_bf16 v[76:79], v[108:111], v[112:115], v[76:79]
    ds_read_b64 v[158:159], v8 offset:3176
    s_waitcnt lgkmcnt(1)
    v_add_u32 v8, 128, v8
    v_subrev_u32 v9, 192, v9
    s_waitcnt lgkmcnt(12)
    v_mfma_f32_16x16x32_bf16 v[48:51], v[128:131], v[160:163], v[48:51]
    ds_read_b64 v[80:81], v8 offset:0
    v_mfma_f32_16x16x32_bf16 v[52:55], v[132:135], v[160:163], v[52:55]
    ds_read_b64 v[82:83], v8 offset:8
    v_mfma_f32_16x16x32_bf16 v[56:59], v[128:131], v[164:167], v[56:59]
    ds_read_b64 v[84:85], v8 offset:32
    v_mfma_f32_16x16x32_bf16 v[60:63], v[132:135], v[164:167], v[60:63]
    ds_read_b64 v[86:87], v8 offset:40
    s_waitcnt lgkmcnt(1)
    v_mfma_f32_16x16x32_bf16 v[64:67], v[128:131], v[168:171], v[64:67]
    ds_read_b128 v[112:115], v9 offset:96
    v_mfma_f32_16x16x32_bf16 v[68:71], v[132:135], v[168:171], v[68:71]
    ds_read_b128 v[116:119], v9 offset:1632
    v_mfma_f32_16x16x32_bf16 v[72:75], v[128:131], v[172:175], v[72:75]
    ds_read_b128 v[120:123], v9 offset:3168
    v_mfma_f32_16x16x32_bf16 v[76:79], v[132:135], v[172:175], v[76:79]
    ds_read_b128 v[124:127], v9 offset:4704
    s_waitcnt lgkmcnt(1)
    s_waitcnt lgkmcnt(15)
    v_mfma_f32_16x16x32_bf16 v[56:59], v[136:139], v[160:163], v[56:59]
    ds_read_b64 v[88:89], v8 offset:1024
    v_mfma_f32_16x16x32_bf16 v[60:63], v[140:143], v[160:163], v[60:63]
    ds_read_b64 v[90:91], v8 offset:1032
    v_mfma_f32_16x16x32_bf16 v[64:67], v[136:139], v[164:167], v[64:67]
    ds_read_b64 v[92:93], v8 offset:1056
    v_mfma_f32_16x16x32_bf16 v[68:71], v[140:143], v[164:167], v[68:71]
    ds_read_b64 v[94:95], v8 offset:1064
    s_waitcnt lgkmcnt(1)
    v_mfma_f32_16x16x32_bf16 v[72:75], v[136:139], v[168:171], v[72:75]
    ds_read_b64 v[96:97], v8 offset:2048
    v_mfma_f32_16x16x32_bf16 v[76:79], v[140:143], v[168:171], v[76:79]
    ds_read_b64 v[98:99], v8 offset:2056
    s_waitcnt lgkmcnt(15)
    v_mfma_f32_16x16x32_bf16 v[64:67], v[144:147], v[160:163], v[64:67]
    ds_read_b64 v[100:101], v8 offset:2080
    v_mfma_f32_16x16x32_bf16 v[68:71], v[148:151], v[160:163], v[68:71]
    ds_read_b64 v[102:103], v8 offset:2088
    s_waitcnt lgkmcnt(1)
    v_mfma_f32_16x16x32_bf16 v[72:75], v[144:147], v[164:167], v[72:75]
    ds_read_b64 v[104:105], v8 offset:3072
    v_mfma_f32_16x16x32_bf16 v[76:79], v[148:151], v[164:167], v[76:79]
    ds_read_b64 v[106:107], v8 offset:3080
    s_waitcnt lgkmcnt(15)
    v_mfma_f32_16x16x32_bf16 v[72:75], v[152:155], v[160:163], v[72:75]
    ds_read_b64 v[108:109], v8 offset:3104
    v_mfma_f32_16x16x32_bf16 v[76:79], v[156:159], v[160:163], v[76:79]
    ds_read_b64 v[110:111], v8 offset:3112
    s_waitcnt lgkmcnt(1)
    s_sub_u32 s26, s26, 1
    s_cmp_lg_u32 s26, 0
    s_cbranch_scc1 f1_kernel_cv0
    s_waitcnt lgkmcnt(0)
    s_mov_b32 s26, 4
.p2align 6
f1_kernel_cv:
    s_waitcnt lgkmcnt(12)
    v_mfma_f32_16x16x32_bf16 v[48:51], v[80:83], v[112:115], v[48:51]
    ds_read_b64 v[128:129], v8 offset:64
    v_mfma_f32_16x16x32_bf16 v[52:55], v[84:87], v[112:115], v[52:55]
    ds_read_b64 v[130:131], v8 offset:72
    v_mfma_f32_16x16x32_bf16 v[56:59], v[80:83], v[116:119], v[56:59]
    ds_read_b64 v[132:133], v8 offset:96
    v_mfma_f32_16x16x32_bf16 v[60:63], v[84:87], v[116:119], v[60:63]
    ds_read_b64 v[134:135], v8 offset:104
    v_mfma_f32_16x16x32_bf16 v[64:67], v[80:83], v[120:123], v[64:67]
    ds_read_b128 v[160:163], v9 offset:0
    v_mfma_f32_16x16x32_bf16 v[68:71], v[84:87], v[120:123], v[68:71]
    ds_read_b128 v[164:167], v9 offset:1536
    v_mfma_f32_16x16x32_bf16 v[72:75], v[80:83], v[124:127], v[72:75]
    ds_read_b128 v[168:171], v9 offset:3072
    v_mfma_f32_16x16x32_bf16 v[76:79], v[84:87], v[124:127], v[76:79]
    ds_read_b128 v[172:175], v9 offset:4608
    s_waitcnt lgkmcnt(15)
    v_mfma_f32_16x16x32_bf16 v[56:59], v[88:91], v[112:115], v[56:59]
    ds_read_b64 v[136:137], v8 offset:1088
    v_mfma_f32_16x16x32_bf16 v[60:63], v[92:95], v[112:115], v[60:63]
    ds_read_b64 v[138:139], v8 offset:1096
    v_mfma_f32_16x16x32_bf16 v[64:67], v[88:91], v[116:119], v[64:67]
    ds_read_b64 v[140:141], v8 offset:1120
    v_mfma_f32_16x16x32_bf16 v[68:71], v[92:95], v[116:119], v[68:71]
    ds_read_b64 v[142:143], v8 offset:1128
    v_mfma_f32_16x16x32_bf16 v[72:75], v[88:91], v[120:123], v[72:75]
    ds_read_b64 v[144:145], v8 offset:2112
    v_mfma_f32_16x16x32_bf16 v[76:79], v[92:95], v[120:123], v[76:79]
    ds_read_b64 v[146:147], v8 offset:2120
    s_waitcnt lgkmcnt(15)
    v_mfma_f32_16x16x32_bf16 v[64:67], v[96:99], v[112:115], v[64:67]
    ds_read_b64 v[148:149], v8 offset:2144
    v_mfma_f32_16x16x32_bf16 v[68:71], v[100:103], v[112:115], v[68:71]
    ds_read_b64 v[150:151], v8 offset:2152
    v_mfma_f32_16x16x32_bf16 v[72:75], v[96:99], v[116:119], v[72:75]
    ds_read_b64 v[152:153], v8 offset:3136
    v_mfma_f32_16x16x32_bf16 v[76:79], v[100:103], v[116:119], v[76:79]
    ds_read_b64 v[154:155], v8 offset:3144
    s_waitcnt lgkmcnt(15)
    v_mfma_f32_16x16x32_bf16 v[72:75], v[104:107], v[112:115], v[72:75]
    ds_read_b64 v[156:157], v8 offset:3168
    v_mfma_f32_16x16x32_bf16 v[76:79], v[108:111], v[112:115], v[76:79]
    ds_read_b64 v[158:159], v8 offset:3176
    v_add_u32 v8, 128, v8
    v_subrev_u32 v9, 192, v9
    s_waitcnt lgkmcnt(12)
    v_mfma_f32_16x16x32_bf16 v[48:51], v[128:131], v[160:163], v[48:51]
    ds_read_b64 v[80:81], v8 offset:0
    v_mfma_f32_16x16x32_bf16 v[52:55], v[132:135], v[160:163], v[52:55]
    ds_read_b64 v[82:83], v8 offset:8
    v_mfma_f32_16x16x32_bf16 v[56:59], v[128:131], v[164:167], v[56:59]
    ds_read_b64 v[84:85], v8 offset:32
    v_mfma_f32_16x16x32_bf16 v[60:63], v[132:135], v[164:167], v[60:63]
    ds_read_b64 v[86:87], v8 offset:40
    v_mfma_f32_16x16x32_bf16 v[64:67], v[128:131], v[168:171], v[64:67]
    ds_read_b128 v[112:115], v9 offset:96
    v_mfma_f32_16x16x32_bf16 v[68:71], v[132:135], v[168:171], v[68:71]
    ds_read_b128 v[116:119], v9 offset:1632
    v_mfma_f32_16x16x32_bf16 v[72:75], v[128:131], v[172:175], v[72:75]
    ds_read_b128 v[120:123], v9 offset:3168
    v_mfma_f32_16x16x32_bf16 v[76:79], v[132:135], v[172:175], v[76:79]
    ds_read_b128 v[124:127], v9 offset:4704
    s_waitcnt lgkmcnt(15)
    v_mfma_f32_16x16x32_bf16 v[56:59], v[136:139], v[160:163], v[56:59]
    ds_read_b64 v[88:89], v8 offset:1024
    v_mfma_f32_16x16x32_bf16 v[60:63], v[140:143], v[160:163], v[60:63]
    ds_read_b64 v[90:91], v8 offset:1032
    v_mfma_f32_16x16x32_bf16 v[64:67], v[136:139], v[164:167], v[64:67]
    ds_read_b64 v[92:93], v8 offset:1056
    v_mfma_f32_16x16x32_bf16 v[68:71], v[140:143], v[164:167], v[68:71]
    ds_read_b64 v[94:95], v8 offset:1064
    v_mfma_f32_16x16x32_bf16 v[72:75], v[136:139], v[168:171], v[72:75]
    ds_read_b64 v[96:97], v8 offset:2048
    v_mfma_f32_16x16x32_bf16 v[76:79], v[140:143], v[168:171], v[76:79]
    ds_read_b64 v[98:99], v8 offset:2056
    s_waitcnt lgkmcnt(15)
    v_mfma_f32_16x16x32_bf16 v[64:67], v[144:147], v[160:163], v[64:67]
    ds_read_b64 v[100:101], v8 offset:2080
    v_mfma_f32_16x16x32_bf16 v[68:71], v[148:151], v[160:163], v[68:71]
    ds_read_b64 v[102:103], v8 offset:2088
    v_mfma_f32_16x16x32_bf16 v[72:75], v[144:147], v[164:167], v[72:75]
    ds_read_b64 v[104:105], v8 offset:3072
    v_mfma_f32_16x16x32_bf16 v[76:79], v[148:151], v[164:167], v[76:79]
    ds_read_b64 v[106:107], v8 offset:3080
    s_waitcnt lgkmcnt(15)
    v_mfma_f32_16x16x32_bf16 v[72:75], v[152:155], v[160:163], v[72:75]
    ds_read_b64 v[108:109], v8 offset:3104
    v_mfma_f32_16x16x32_bf16 v[76:79], v[156:159], v[160:163], v[76:79]
    ds_read_b64 v[110:111], v8 offset:3112
    s_sub_u32 s26, s26, 1
    s_cmp_lg_u32 s26, 0
    s_cbranch_scc1 f1_kernel_cv
    v_mul_u32_u24 v10, 80, v6
    v_lshl_add_u32 v10, v7, 3, v10
    v_add_u32 v10, s62, v10
    s_add_u32 s16, s4, 0x400000
    s_addc_u32 s17, s5, 0
    s_mov_b32 s18, 0x400000
    s_mov_b32 s19, 0x20000
    s_waitcnt lgkmcnt(0)
    v_cvt_pk_bf16_f32 v16, v48, v49
    v_cvt_pk_bf16_f32 v17, v50, v51
    ds_write_b64 v10, v[16:17] offset:0
    v_cvt_pk_bf16_f32 v18, v52, v53
    v_cvt_pk_bf16_f32 v19, v54, v55
    ds_write_b64 v10, v[18:19] offset:32
    v_cvt_pk_bf16_f32 v20, v56, v57
    v_cvt_pk_bf16_f32 v21, v58, v59
    ds_write_b64 v10, v[20:21] offset:1280
    v_cvt_pk_bf16_f32 v22, v60, v61
    v_cvt_pk_bf16_f32 v23, v62, v63
    ds_write_b64 v10, v[22:23] offset:1312
    v_cvt_pk_bf16_f32 v24, v64, v65
    v_cvt_pk_bf16_f32 v25, v66, v67
    ds_write_b64 v10, v[24:25] offset:2560
    v_cvt_pk_bf16_f32 v26, v68, v69
    v_cvt_pk_bf16_f32 v27, v70, v71
    ds_write_b64 v10, v[26:27] offset:2592
    v_cvt_pk_bf16_f32 v28, v72, v73
    v_cvt_pk_bf16_f32 v29, v74, v75
    ds_write_b64 v10, v[28:29] offset:3840
    v_cvt_pk_bf16_f32 v30, v76, v77
    v_cvt_pk_bf16_f32 v31, v78, v79
    ds_write_b64 v10, v[30:31] offset:3872
    v_lshrrev_b32 v11, 4, v0
    v_mul_u32_u24 v11, 80, v11
    v_lshl_add_u32 v11, v6, 2, v11
    v_add_u32 v13, 72960, v11
    v_lshlrev_b32 v12, 4, v0
    s_lshl_b32 s25, s21, 14
    s_mov_b32 s34, 0x05040100
    s_mov_b32 s35, 0x07060302
    s_waitcnt lgkmcnt(0)
    v_mov_b32 v15, 1
    ds_add_u32 v14, v15
f1_kernel_ys:
    ds_read_b32 v15, v14
    s_waitcnt lgkmcnt(0)
    v_cmp_ne_u32 vcc, 256, v15
    s_nop 1
    s_cbranch_vccnz f1_kernel_ys
    ds_read_b32 v48, v11 offset:0
    ds_read_b32 v49, v11 offset:24320
    ds_read_b32 v50, v11 offset:48640
    ds_read_b32 v51, v13 offset:0
    ds_read_b32 v52, v11 offset:1280
    ds_read_b32 v53, v11 offset:25600
    ds_read_b32 v54, v11 offset:49920
    ds_read_b32 v55, v13 offset:1280
    ds_read_b32 v56, v11 offset:2560
    ds_read_b32 v57, v11 offset:26880
    ds_read_b32 v58, v11 offset:51200
    ds_read_b32 v59, v13 offset:2560
    ds_read_b32 v60, v11 offset:3840
    ds_read_b32 v61, v11 offset:28160
    ds_read_b32 v62, v11 offset:52480
    ds_read_b32 v63, v13 offset:3840
    s_waitcnt lgkmcnt(12)
    v_perm_b32 v64, v49, v48, s34
    v_perm_b32 v65, v51, v50, s34
    v_perm_b32 v66, v49, v48, s35
    v_perm_b32 v67, v51, v50, s35
    s_add_u32 s26, s25, 0
    buffer_store_dwordx4 v[64:67], v12, s[16:19], s26 offen sc0 sc1
    s_waitcnt lgkmcnt(8)
    v_perm_b32 v68, v53, v52, s34
    v_perm_b32 v69, v55, v54, s34
    v_perm_b32 v70, v53, v52, s35
    v_perm_b32 v71, v55, v54, s35
    s_add_u32 s26, s25, 4096
    buffer_store_dwordx4 v[68:71], v12, s[16:19], s26 offen sc0 sc1
    s_waitcnt lgkmcnt(4)
    v_perm_b32 v72, v57, v56, s34
    v_perm_b32 v73, v59, v58, s34
    v_perm_b32 v74, v57, v56, s35
    v_perm_b32 v75, v59, v58, s35
    s_add_u32 s26, s25, 8192
    buffer_store_dwordx4 v[72:75], v12, s[16:19], s26 offen sc0 sc1
    s_waitcnt lgkmcnt(0)
    v_perm_b32 v76, v61, v60, s34
    v_perm_b32 v77, v63, v62, s34
    v_perm_b32 v78, v61, v60, s35
    v_perm_b32 v79, v63, v62, s35
    s_add_u32 s26, s25, 12288
    buffer_store_dwordx4 v[76:79], v12, s[16:19], s26 offen sc0 sc1
    s_lshl_b32 s22, s2, 10
    v_mov_b32 v15, 1
    s_waitcnt vmcnt(0)
    s_mov_b64 exec, 1
    ds_add_rtn_u32 v15, v14, v15 offset:28
    s_waitcnt lgkmcnt(0)
    v_cmp_eq_u32 vcc, 3, v15
    v_mov_b32 v15, s83
    s_nop 0
    s_cbranch_vccz f1_kernel_ay
    buffer_store_dword v15, off, s[56:59], s22 offset:896 sc0 sc1
f1_kernel_ay:
    s_mov_b64 exec, -1
    s_mov_b32 s27, 0xffff0000
    s_lshr_b32 s52, s20, 1
    v_lshrrev_b32 v196, 1, v2
    v_xor_b32 v196, s52, v196
    v_and_b32 v196, 3, v196
    v_lshlrev_b32 v196, 4, v196
    v_lshl_add_u32 v196, v2, 7, v196
    s_and_b32 s52, s20, 1
    s_lshl_b32 s52, s52, 3
    s_add_u32 s52, s52, 135168
    v_add_u32 v196, s52, v196
    v_add_u32 v197, 151552, v3
    v_lshlrev_b32 v176, 16, v232
    v_and_b32 v177, s27, v232
    v_lshlrev_b32 v178, 16, v233
    v_and_b32 v179, s27, v233
    v_lshlrev_b32 v180, 16, v234
    v_and_b32 v181, s27, v234
    v_lshlrev_b32 v182, 16, v235
    v_and_b32 v183, s27, v235
    v_lshlrev_b32 v184, 16, v236
    v_and_b32 v185, s27, v236
    v_lshlrev_b32 v186, 16, v237
    v_and_b32 v187, s27, v237
    v_lshlrev_b32 v188, 16, v238
    v_and_b32 v189, s27, v238
    v_lshlrev_b32 v190, 16, v239
    v_and_b32 v191, s27, v239
    v_pk_add_f32 v[96:97], v[176:177], v[178:179]
    v_pk_mul_f32 v[98:99], v[176:177], v[176:177]
    v_pk_fma_f32 v[98:99], v[178:179], v[178:179], v[98:99]
    v_pk_add_f32 v[96:97], v[96:97], v[180:181]
    v_pk_fma_f32 v[98:99], v[180:181], v[180:181], v[98:99]
    v_pk_add_f32 v[96:97], v[96:97], v[182:183]
    v_pk_fma_f32 v[98:99], v[182:183], v[182:183], v[98:99]
    v_pk_add_f32 v[96:97], v[96:97], v[184:185]
    v_pk_fma_f32 v[98:99], v[184:185], v[184:185], v[98:99]
    v_pk_add_f32 v[96:97], v[96:97], v[186:187]
    v_pk_fma_f32 v[98:99], v[186:187], v[186:187], v[98:99]
    v_pk_add_f32 v[96:97], v[96:97], v[188:189]
    v_pk_fma_f32 v[98:99], v[188:189], v[188:189], v[98:99]
    v_pk_add_f32 v[96:97], v[96:97], v[190:191]
    v_pk_fma_f32 v[98:99], v[190:191], v[190:191], v[98:99]
    v_add_f32 v100, v96, v97
    v_add_f32 v101, v98, v99
    s_nop 0
    v_add_f32_dpp v100, v100, v100 row_shr:1 row_mask:0xf bank_mask:0xf bound_ctrl:0
    v_add_f32_dpp v101, v101, v101 row_shr:1 row_mask:0xf bank_mask:0xf bound_ctrl:0
    s_nop 0
    v_add_f32_dpp v100, v100, v100 row_shr:2 row_mask:0xf bank_mask:0xf bound_ctrl:0
    v_add_f32_dpp v101, v101, v101 row_shr:2 row_mask:0xf bank_mask:0xf bound_ctrl:0
    s_nop 0
    v_add_f32_dpp v100, v100, v100 row_shr:4 row_mask:0xf bank_mask:0xf bound_ctrl:0
    v_add_f32_dpp v101, v101, v101 row_shr:4 row_mask:0xf bank_mask:0xf bound_ctrl:0
    s_nop 0
    v_add_f32_dpp v100, v100, v100 row_shr:8 row_mask:0xf bank_mask:0xf bound_ctrl:0
    v_add_f32_dpp v101, v101, v101 row_shr:8 row_mask:0xf bank_mask:0xf bound_ctrl:0
    s_nop 0
    v_add_f32_dpp v100, v100, v100 row_bcast:15 row_mask:0xa bank_mask:0xf
    v_add_f32_dpp v101, v101, v101 row_bcast:15 row_mask:0xa bank_mask:0xf
    s_nop 0
    v_add_f32_dpp v100, v100, v100 row_bcast:31 row_mask:0xc bank_mask:0xf
    v_add_f32_dpp v101, v101, v101 row_bcast:31 row_mask:0xc bank_mask:0xf
    s_nop 0
    v_readlane_b32 s52, v100, 63
    v_readlane_b32 s53, v101, 63
    v_mov_b32 v98, 0x3a800000
    s_nop 0
    v_mul_f32 v96, s52, v98
    v_mul_f32 v97, s53, v98
    v_fma_f32 v97, -v96, v96, v97
    v_max_f32 v97, 0, v97
    v_add_f32 v97, 0x3727c5ac, v97
    v_rsq_f32 v192, v97
    s_nop 0
    v_mul_f32 v194, -v96, v192
    v_lshrrev_b32 v4, 4, v2
    v_xor_b32 v4, v4, v2
    v_and_b32 v4, 3, v4
    v_lshlrev_b32 v4, 4, v4
    v_lshrrev_b32 v5, 2, v2
    v_lshl_add_u32 v4, v5, 14, v4
    s_lshl_b32 s23, s21, 6
    s_lshl_b32 s24, s20, 20
    s_add_u32 s23, s23, s24
    s_add_u32 s12, s4, 0x400000
    s_addc_u32 s13, s5, 0
    s_mov_b32 s14, 0x400000
    s_mov_b32 s15, 0x20000
    s_lshl_b32 s24, s20, 12
    s_add_u32 m0, s24, 135168
    s_cmp_lg_u32 s20, 0
    s_cbranch_scc1 f1_kernel_gw
    v_mov_b32 v13, s83
    v_lshlrev_b32 v12, 10, v2
    v_add_u32 v12, 896, v12
    s_mov_b32 s39, 0x40000
    s_mov_b64 s[44:45], -1
    s_mov_b64 s[46:47], -1
    v_add_u32 v21, 65536, v12
    s_mov_b64 s[52:53], -1
    v_add_u32 v22, 131072, v12
    s_mov_b64 s[54:55], -1
    v_add_u32 v23, 196608, v12
    s_branch f1_kernel_pg_in
f1_kernel_pg:
    s_sleep 2
f1_kernel_pg_in:
    s_or_b64 exec, s[44:45], 1
    buffer_load_dword v16, v12, s[56:59], 0 offen sc0 sc1
    s_or_b64 exec, s[46:47], 1
    buffer_load_dword v17, v21, s[56:59], 0 offen sc0 sc1
    s_or_b64 exec, s[52:53], 1
    buffer_load_dword v18, v22, s[56:59], 0 offen sc0 sc1
    s_or_b64 exec, s[54:55], 1
    buffer_load_dword v19, v23, s[56:59], 0 offen sc0 sc1
    s_sub_u32 s39, s39, 1
    s_cmp_eq_u32 s39, 0
    s_cbranch_scc1 f1_kernel_pg_out
    s_waitcnt vmcnt(0)
    s_or_b64 exec, s[44:45], 1
    v_cmp_ne_u32 s[44:45], s83, v16
    s_or_b64 exec, s[46:47], 1
    v_cmp_ne_u32 s[46:47], s83, v17
    s_or_b64 exec, s[52:53], 1
    v_cmp_ne_u32 s[52:53], s83, v18
    s_or_b64 exec, s[54:55], 1
    v_cmp_ne_u32 s[54:55], s83, v19
    s_nop 1
    s_or_b64 vcc, s[44:45], s[46:47]
    s_or_b64 vcc, vcc, s[52:53]
    s_or_b64 vcc, vcc, s[54:55]
    s_cbranch_scc1 f1_kernel_pg
f1_kernel_pg_out:
    s_mov_b64 exec, -1
    v_mov_b32 v15, 1
    ds_write_b32 v14, v15 offset:36
    s_branch f1_kernel_gx
f1_kernel_gw:
    ds_read_b32 v15, v14 offset:36
    s_waitcnt lgkmcnt(0)
    v_cmp_ne_u32 vcc, 1, v15
    s_nop 1
    s_cbranch_vccnz f1_kernel_gw
f1_kernel_gx:
    buffer_load_dwordx4 v4, s[12:15], s23 offen sc0 sc1 lds
    s_add_u32 m0, m0, 1024
    s_add_u32 s23, s23, 0x40000
    buffer_load_dwordx4 v4, s[12:15], s23 offen sc0 sc1 lds
    s_add_u32 m0, m0, 1024
    s_add_u32 s23, s23, 0x40000
    buffer_load_dwordx4 v4, s[12:15], s23 offen sc0 sc1 lds
    s_add_u32 m0, m0, 1024
    s_add_u32 s23, s23, 0x40000
    buffer_load_dwordx4 v4, s[12:15], s23 offen sc0 sc1 lds
    s_add_u32 m0, m0, 1024
    s_add_u32 s23, s23, 0x40000
    s_or_b32 s24, s2, s20
    s_cmp_lg_u32 s24, 0
    s_cbranch_scc1 f1_kernel_gb
    v_mov_b32 v12, 458804
    buffer_store_dword v13, v12, s[56:59], 0 offen sc0 sc1
f1_kernel_gb:
    s_add_u32 s28, s4, 0xc00000
    s_addc_u32 s29, s5, 0
    s_mov_b32 s30, 0x400000
    s_mov_b32 s31, 0x20000
    s_add_u32 s32, s4, 0x800000
    s_addc_u32 s33, s5, 0
    s_mov_b32 s34, 0x400000
    s_mov_b32 s35, 0x20000
    s_mov_b32 s27, 0xffff0000
    v_pk_fma_f32 v[144:145], v[176:177], v[192:193], v[194:195] op_sel_hi:[1,0,0]
    v_pk_fma_f32 v[146:147], v[178:179], v[192:193], v[194:195] op_sel_hi:[1,0,0]
    v_pk_fma_f32 v[148:149], v[180:181], v[192:193], v[194:195] op_sel_hi:[1,0,0]
    v_pk_fma_f32 v[150:151], v[182:183], v[192:193], v[194:195] op_sel_hi:[1,0,0]
    v_pk_fma_f32 v[152:153], v[184:185], v[192:193], v[194:195] op_sel_hi:[1,0,0]
    v_pk_fma_f32 v[154:155], v[186:187], v[192:193], v[194:195] op_sel_hi:[1,0,0]
    v_pk_fma_f32 v[156:157], v[188:189], v[192:193], v[194:195] op_sel_hi:[1,0,0]
    v_pk_fma_f32 v[158:159], v[190:191], v[192:193], v[194:195] op_sel_hi:[1,0,0]
    s_barrier
    ds_read_b128 v[40:43], v197 offset:2048
    ds_read_b128 v[44:47], v197 offset:3072
    ds_read_b128 v[32:35], v197 offset:0
    ds_read_b128 v[36:39], v197 offset:1024
    ds_read_b128 v[48:51], v197 offset:4096
    ds_read_b128 v[52:55], v197 offset:5120
    ds_read_b128 v[64:67], v197 offset:8192
    ds_read_b128 v[68:71], v197 offset:9216
    ds_read_b128 v[56:59], v197 offset:6144
    ds_read_b128 v[60:63], v197 offset:7168
    s_waitcnt lgkmcnt(6)
    v_lshlrev_b32 v104, 16, v40
    v_and_b32 v105, s27, v40
    v_lshlrev_b32 v88, 16, v32
    v_and_b32 v89, s27, v32
    v_pk_fma_f32 v[144:145], v[144:145], v[104:105], v[88:89]
    v_lshlrev_b32 v106, 16, v41
    v_and_b32 v107, s27, v41
    v_lshlrev_b32 v90, 16, v33
    v_and_b32 v91, s27, v33
    v_pk_fma_f32 v[146:147], v[146:147], v[106:107], v[90:91]
    v_lshlrev_b32 v108, 16, v42
    v_and_b32 v109, s27, v42
    v_lshlrev_b32 v92, 16, v34
    v_and_b32 v93, s27, v34
    v_pk_fma_f32 v[148:149], v[148:149], v[108:109], v[92:93]
    v_lshlrev_b32 v110, 16, v43
    v_and_b32 v111, s27, v43
    v_lshlrev_b32 v94, 16, v35
    v_and_b32 v95, s27, v35
    v_pk_fma_f32 v[150:151], v[150:151], v[110:111], v[94:95]
    v_lshlrev_b32 v112, 16, v44
    v_and_b32 v113, s27, v44
    v_lshlrev_b32 v96, 16, v36
    v_and_b32 v97, s27, v36
    v_pk_fma_f32 v[152:153], v[152:153], v[112:113], v[96:97]
    v_lshlrev_b32 v114, 16, v45
    v_and_b32 v115, s27, v45
    v_lshlrev_b32 v98, 16, v37
    v_and_b32 v99, s27, v37
    v_pk_fma_f32 v[154:155], v[154:155], v[114:115], v[98:99]
    v_lshlrev_b32 v116, 16, v46
    v_and_b32 v117, s27, v46
    v_lshlrev_b32 v100, 16, v38
    v_and_b32 v101, s27, v38
    v_pk_fma_f32 v[156:157], v[156:157], v[116:117], v[100:101]
    v_lshlrev_b32 v118, 16, v47
    v_and_b32 v119, s27, v47
    v_lshlrev_b32 v102, 16, v39
    v_and_b32 v103, s27, v39
    v_pk_fma_f32 v[158:159], v[158:159], v[118:119], v[102:103]
    s_waitcnt lgkmcnt(4)
    v_lshlrev_b32 v120, 16, v48
    v_and_b32 v121, s27, v48
    v_pk_mul_f32 v[144:145], v[144:145], v[120:121]
    v_lshlrev_b32 v122, 16, v49
    v_and_b32 v123, s27, v49
    v_pk_mul_f32 v[146:147], v[146:147], v[122:123]
    v_lshlrev_b32 v124, 16, v50
    v_and_b32 v125, s27, v50
    v_pk_mul_f32 v[148:149], v[148:149], v[124:125]
    v_lshlrev_b32 v126, 16, v51
    v_and_b32 v127, s27, v51
    v_pk_mul_f32 v[150:151], v[150:151], v[126:127]
    v_lshlrev_b32 v128, 16, v52
    v_and_b32 v129, s27, v52
    v_pk_mul_f32 v[152:153], v[152:153], v[128:129]
    v_lshlrev_b32 v130, 16, v53
    v_and_b32 v131, s27, v53
    v_pk_mul_f32 v[154:155], v[154:155], v[130:131]
    v_lshlrev_b32 v132, 16, v54
    v_and_b32 v133, s27, v54
    v_pk_mul_f32 v[156:157], v[156:157], v[132:133]
    v_lshlrev_b32 v134, 16, v55
    v_and_b32 v135, s27, v55
    v_pk_mul_f32 v[158:159], v[158:159], v[134:135]
    s_waitcnt lgkmcnt(0)
    v_lshlrev_b32 v104, 16, v64
    v_and_b32 v105, s27, v64
    v_lshlrev_b32 v88, 16, v56
    v_and_b32 v89, s27, v56
    v_lshlrev_b32 v106, 16, v65
    v_and_b32 v107, s27, v65
    v_lshlrev_b32 v90, 16, v57
    v_and_b32 v91, s27, v57
    v_lshlrev_b32 v108, 16, v66
    v_and_b32 v109, s27, v66
    v_lshlrev_b32 v92, 16, v58
    v_and_b32 v93, s27, v58
    v_lshlrev_b32 v110, 16, v67
    v_and_b32 v111, s27, v67
    v_lshlrev_b32 v94, 16, v59
    v_and_b32 v95, s27, v59
    v_lshlrev_b32 v112, 16, v68
    v_and_b32 v113, s27, v68
    v_lshlrev_b32 v96, 16, v60
    v_and_b32 v97, s27, v60
    v_lshlrev_b32 v114, 16, v69
    v_and_b32 v115, s27, v69
    v_lshlrev_b32 v98, 16, v61
    v_and_b32 v99, s27, v61
    v_lshlrev_b32 v116, 16, v70
    v_and_b32 v117, s27, v70
    v_lshlrev_b32 v100, 16, v62
    v_and_b32 v101, s27, v62
    v_lshlrev_b32 v118, 16, v71
    v_and_b32 v119, s27, v71
    v_lshlrev_b32 v102, 16, v63
    v_and_b32 v103, s27, v63
    s_waitcnt vmcnt(0)
    s_barrier
    ds_read_b64 v[24:25], v196 offset:0
    ds_read_b64 v[26:27], v196 offset:64
    ds_read_b64 v[28:29], v196 offset:8192
    ds_read_b64 v[30:31], v196 offset:8256
    s_waitcnt lgkmcnt(3)
    v_lshlrev_b32 v136, 16, v24
    v_and_b32 v137, s27, v24
    v_pk_fma_f32 v[144:145], v[144:145], v[136:137], v[176:177]
    v_cvt_pk_bf16_f32 v16, v144, v145
    v_lshlrev_b32 v176, 16, v16
    v_and_b32 v177, s27, v16
    v_lshlrev_b32 v138, 16, v25
    v_and_b32 v139, s27, v25
    v_pk_fma_f32 v[146:147], v[146:147], v[138:139], v[178:179]
    v_cvt_pk_bf16_f32 v17, v146, v147
    v_lshlrev_b32 v178, 16, v17
    v_and_b32 v179, s27, v17
    s_waitcnt lgkmcnt(2)
    v_lshlrev_b32 v136, 16, v26
    v_and_b32 v137, s27, v26
    v_pk_fma_f32 v[148:149], v[148:149], v[136:137], v[180:181]
    v_cvt_pk_bf16_f32 v18, v148, v149
    v_lshlrev_b32 v180, 16, v18
    v_and_b32 v181, s27, v18
    v_lshlrev_b32 v138, 16, v27
    v_and_b32 v139, s27, v27
    v_pk_fma_f32 v[150:151], v[150:151], v[138:139], v[182:183]
    v_cvt_pk_bf16_f32 v19, v150, v151
    v_lshlrev_b32 v182, 16, v19
    v_and_b32 v183, s27, v19
    s_waitcnt lgkmcnt(1)
    v_lshlrev_b32 v136, 16, v28
    v_and_b32 v137, s27, v28
    v_pk_fma_f32 v[152:153], v[152:153], v[136:137], v[184:185]
    v_cvt_pk_bf16_f32 v20, v152, v153
    v_lshlrev_b32 v184, 16, v20
    v_and_b32 v185, s27, v20
    v_lshlrev_b32 v138, 16, v29
    v_and_b32 v139, s27, v29
    v_pk_fma_f32 v[154:155], v[154:155], v[138:139], v[186:187]
    v_cvt_pk_bf16_f32 v21, v154, v155
    v_lshlrev_b32 v186, 16, v21
    v_and_b32 v187, s27, v21
    s_waitcnt lgkmcnt(0)
    v_lshlrev_b32 v136, 16, v30
    v_and_b32 v137, s27, v30
    v_pk_fma_f32 v[156:157], v[156:157], v[136:137], v[188:189]
    v_cvt_pk_bf16_f32 v22, v156, v157
    v_lshlrev_b32 v188, 16, v22
    v_and_b32 v189, s27, v22
    v_lshlrev_b32 v138, 16, v31
    v_and_b32 v139, s27, v31
    v_pk_fma_f32 v[158:159], v[158:159], v[138:139], v[190:191]
    v_cvt_pk_bf16_f32 v23, v158, v159
    v_lshlrev_b32 v190, 16, v23
    v_and_b32 v191, s27, v23
    buffer_store_dwordx4 v[16:19], v3, s[28:31], s61 offen offset:0 sc0 sc1
    buffer_store_dwordx4 v[20:23], v3, s[28:31], s61 offen offset:1024 sc0 sc1
    v_pk_add_f32 v[8:9], v[176:177], v[178:179]
    v_pk_mul_f32 v[10:11], v[176:177], v[176:177]
    v_pk_fma_f32 v[10:11], v[178:179], v[178:179], v[10:11]
    v_pk_add_f32 v[8:9], v[8:9], v[180:181]
    v_pk_fma_f32 v[10:11], v[180:181], v[180:181], v[10:11]
    v_pk_add_f32 v[8:9], v[8:9], v[182:183]
    v_pk_fma_f32 v[10:11], v[182:183], v[182:183], v[10:11]
    v_pk_add_f32 v[8:9], v[8:9], v[184:185]
    v_pk_fma_f32 v[10:11], v[184:185], v[184:185], v[10:11]
    v_pk_add_f32 v[8:9], v[8:9], v[186:187]
    v_pk_fma_f32 v[10:11], v[186:187], v[186:187], v[10:11]
    v_pk_add_f32 v[8:9], v[8:9], v[188:189]
    v_pk_fma_f32 v[10:11], v[188:189], v[188:189], v[10:11]
    v_pk_add_f32 v[8:9], v[8:9], v[190:191]
    v_pk_fma_f32 v[10:11], v[190:191], v[190:191], v[10:11]
    v_add_f32 v12, v8, v9
    v_add_f32 v13, v10, v11
    s_nop 0
    v_add_f32_dpp v12, v12, v12 row_shr:1 row_mask:0xf bank_mask:0xf bound_ctrl:0
    v_add_f32_dpp v13, v13, v13 row_shr:1 row_mask:0xf bank_mask:0xf bound_ctrl:0
    s_nop 0
    v_add_f32_dpp v12, v12, v12 row_shr:2 row_mask:0xf bank_mask:0xf bound_ctrl:0
    v_add_f32_dpp v13, v13, v13 row_shr:2 row_mask:0xf bank_mask:0xf bound_ctrl:0
    s_nop 0
    v_add_f32_dpp v12, v12, v12 row_shr:4 row_mask:0xf bank_mask:0xf bound_ctrl:0
    v_add_f32_dpp v13, v13, v13 row_shr:4 row_mask:0xf bank_mask:0xf bound_ctrl:0
    s_nop 0
    v_add_f32_dpp v12, v12, v12 row_shr:8 row_mask:0xf bank_mask:0xf bound_ctrl:0
    v_add_f32_dpp v13, v13, v13 row_shr:8 row_mask:0xf bank_mask:0xf bound_ctrl:0
    s_nop 0
    v_add_f32_dpp v12, v12, v12 row_bcast:15 row_mask:0xa bank_mask:0xf
    v_add_f32_dpp v13, v13, v13 row_bcast:15 row_mask:0xa bank_mask:0xf
    s_nop 0
    v_add_f32_dpp v12, v12, v12 row_bcast:31 row_mask:0xc bank_mask:0xf
    v_add_f32_dpp v13, v13, v13 row_bcast:31 row_mask:0xc bank_mask:0xf
    s_nop 0
    v_readlane_b32 s52, v12, 63
    v_readlane_b32 s53, v13, 63
    v_mov_b32 v10, 0x3a800000
    s_nop 0
    v_mul_f32 v8, s52, v10
    v_mul_f32 v9, s53, v10
    v_fma_f32 v9, -v8, v8, v9
    v_max_f32 v9, 0, v9
    v_add_f32 v9, 0x3727c5ac, v9
    v_rsq_f32 v192, v9
    s_nop 0
    v_mul_f32 v194, -v8, v192
    v_pk_fma_f32 v[144:145], v[176:177], v[192:193], v[194:195] op_sel_hi:[1,0,0]
    v_pk_fma_f32 v[144:145], v[144:145], v[104:105], v[88:89]
    v_cvt_pk_bf16_f32 v24, v144, v145
    v_pk_fma_f32 v[146:147], v[178:179], v[192:193], v[194:195] op_sel_hi:[1,0,0]
    v_pk_fma_f32 v[146:147], v[146:147], v[106:107], v[90:91]
    v_cvt_pk_bf16_f32 v25, v146, v147
    v_pk_fma_f32 v[148:149], v[180:181], v[192:193], v[194:195] op_sel_hi:[1,0,0]
    v_pk_fma_f32 v[148:149], v[148:149], v[108:109], v[92:93]
    v_cvt_pk_bf16_f32 v26, v148, v149
    v_pk_fma_f32 v[150:151], v[182:183], v[192:193], v[194:195] op_sel_hi:[1,0,0]
    v_pk_fma_f32 v[150:151], v[150:151], v[110:111], v[94:95]
    v_cvt_pk_bf16_f32 v27, v150, v151
    v_pk_fma_f32 v[152:153], v[184:185], v[192:193], v[194:195] op_sel_hi:[1,0,0]
    v_pk_fma_f32 v[152:153], v[152:153], v[112:113], v[96:97]
    v_cvt_pk_bf16_f32 v28, v152, v153
    v_pk_fma_f32 v[154:155], v[186:187], v[192:193], v[194:195] op_sel_hi:[1,0,0]
    v_pk_fma_f32 v[154:155], v[154:155], v[114:115], v[98:99]
    v_cvt_pk_bf16_f32 v29, v154, v155
    v_pk_fma_f32 v[156:157], v[188:189], v[192:193], v[194:195] op_sel_hi:[1,0,0]
    v_pk_fma_f32 v[156:157], v[156:157], v[116:117], v[100:101]
    v_cvt_pk_bf16_f32 v30, v156, v157
    v_pk_fma_f32 v[158:159], v[190:191], v[192:193], v[194:195] op_sel_hi:[1,0,0]
    v_pk_fma_f32 v[158:159], v[158:159], v[118:119], v[102:103]
    v_cvt_pk_bf16_f32 v31, v158, v159
    buffer_store_dwordx4 v[24:27], v3, s[32:35], s61 offen offset:0 sc0 sc1
    buffer_store_dwordx4 v[28:31], v3, s[32:35], s61 offen offset:1024 sc0 sc1
    s_lshl_b32 s22, s21, 10
    v_mov_b32 v8, 161792
    s_and_b32 s28, s20, 1
    s_lshr_b32 s29, s20, 1
    v_and_b32 v110, 15, v2
    v_lshrrev_b32 v12, 4, v2
    v_and_b32 v13, 7, v110
    v_xor_b32 v13, v13, v12
    v_lshlrev_b32 v13, 4, v13
    s_lshl_b32 s27, s28, 13
    s_add_u32 s27, s27, 86016
    v_lshl_add_u32 v4, v110, 7, v13
    v_add_u32 v4, s27, v4
    v_xor_b32 v5, 64, v4
    v_lshrrev_b32 v13, 2, v110
    v_lshl_add_u32 v13, v12, 3, v13
    v_mul_u32_u24 v13, 448, v13
    v_and_b32 v14, 3, v2
    v_lshl_add_u32 v13, v14, 3, v13
    s_mul_i32 s27, s29, 224
    v_add_u32 v13, s27, v13
    v_and_b32 v14, 1, v12
    v_lshlrev_b32 v14, 5, v14
    v_add_u32 v6, v13, v14
    v_sub_u32 v7, v13, v14
    s_cmp_eq_u32 s29, 0
    s_cbranch_scc1 f1_kernel_noswap
    v_swap_b32 v6, v7
f1_kernel_noswap:
    v_mov_b32 v160, 0
    v_mov_b32 v161, 0
    v_mov_b32 v162, 0
    v_mov_b32 v163, 0
    v_mov_b32 v164, 0
    v_mov_b32 v165, 0
    v_mov_b32 v166, 0
    v_mov_b32 v167, 0
    v_mov_b32 v168, 0
    v_mov_b32 v169, 0
    v_mov_b32 v170, 0
    v_mov_b32 v171, 0
    v_mov_b32 v172, 0
    v_mov_b32 v173, 0
    v_mov_b32 v174, 0
    v_mov_b32 v175, 0
    v_mov_b32 v176, 0
    v_mov_b32 v177, 0
    v_mov_b32 v178, 0
    v_mov_b32 v179, 0
    v_mov_b32 v180, 0
    v_mov_b32 v181, 0
    v_mov_b32 v182, 0
    v_mov_b32 v183, 0
    v_mov_b32 v184, 0
    v_mov_b32 v185, 0
    v_mov_b32 v186, 0
    v_mov_b32 v187, 0
    v_mov_b32 v188, 0
    v_mov_b32 v189, 0
    v_mov_b32 v190, 0
    v_mov_b32 v191, 0
    v_mov_b32 v192, 0
    v_mov_b32 v193, 0
    v_mov_b32 v194, 0
    v_mov_b32 v195, 0
    v_mov_b32 v196, 0
    v_mov_b32 v197, 0
    v_mov_b32 v198, 0
    v_mov_b32 v199, 0
    v_mov_b32 v200, 0
    v_mov_b32 v201, 0
    v_mov_b32 v202, 0
    v_mov_b32 v203, 0
    v_mov_b32 v204, 0
    v_mov_b32 v205, 0
    v_mov_b32 v206, 0
    v_mov_b32 v207, 0
    v_mov_b32 v208, 0
    v_mov_b32 v209, 0
    v_mov_b32 v210, 0
    v_mov_b32 v211, 0
    v_mov_b32 v212, 0
    v_mov_b32 v213, 0
    v_mov_b32 v214, 0
    v_mov_b32 v215, 0
    v_mov_b32 v216, 0
    v_mov_b32 v217, 0
    v_mov_b32 v218, 0
    v_mov_b32 v219, 0
    v_mov_b32 v220, 0
    v_mov_b32 v221, 0
    v_mov_b32 v222, 0
    v_mov_b32 v223, 0
    v_mov_b32 v224, 0
    v_mov_b32 v225, 0
    v_mov_b32 v226, 0
    v_mov_b32 v227, 0
    v_mov_b32 v228, 0
    v_mov_b32 v229, 0
    v_mov_b32 v230, 0
    v_mov_b32 v231, 0
    v_mov_b32 v232, 0
    v_mov_b32 v233, 0
    v_mov_b32 v234, 0
    v_mov_b32 v235, 0
    v_mov_b32 v236, 0
    v_mov_b32 v237, 0
    v_mov_b32 v238, 0
    v_mov_b32 v239, 0
    v_mov_b32 v9, 1
    s_waitcnt vmcnt(0)
    s_mov_b64 exec, 1
    ds_add_rtn_u32 v9, v8, v9 offset:20
    s_waitcnt lgkmcnt(0)
    v_cmp_eq_u32 vcc, 7, v9
    v_mov_b32 v9, s83
    s_nop 0
    s_cbranch_vccz f1_kernel_ah
    buffer_store_dword v9, off, s[56:59], s22 offset:512 sc0 sc1
f1_kernel_ah:
    s_mov_b64 exec, -1
    s_mov_b32 s34, s22
    v_mov_b32 v128, 0
    v_mov_b32 v129, 0
    v_mov_b32 v130, 0
    v_mov_b32 v131, 0
    v_mov_b32 v132, 0
    v_mov_b32 v133, 0
    v_mov_b32 v134, 0
    v_mov_b32 v135, 0
    v_mov_b32 v136, 0
    v_mov_b32 v137, 0
    v_mov_b32 v138, 0
    v_mov_b32 v139, 0
    v_mov_b32 v140, 0
    v_mov_b32 v141, 0
    v_mov_b32 v142, 0
    v_mov_b32 v143, 0
    v_mov_b32 v144, 0
    v_mov_b32 v145, 0
    v_mov_b32 v146, 0
    v_mov_b32 v147, 0
    v_mov_b32 v148, 0
    v_mov_b32 v149, 0
    v_mov_b32 v150, 0
    v_mov_b32 v151, 0
    v_mov_b32 v152, 0
    v_mov_b32 v153, 0
    v_mov_b32 v154, 0
    v_mov_b32 v155, 0
    v_mov_b32 v156, 0
    v_mov_b32 v157, 0
    v_mov_b32 v158, 0
    v_mov_b32 v159, 0
    s_and_b32 s21, s2, 1
    s_lshl_b32 s21, s21, 3
    s_bfe_u32 s27, s2, 0x30003
    s_add_u32 s21, s21, s27
    s_bfe_u32 s22, s2, 0x20001
    s_lshl_b32 s22, s22, 2
    s_lshr_b32 s27, s2, 6
    s_add_u32 s22, s22, s27
    s_add_u32 s16, s4, 0x1000000
    s_addc_u32 s17, s5, 0
    s_mov_b32 s18, 0xe00000
    s_mov_b32 s19, 0x20000
    s_mov_b32 s26, 0
    s_mov_b32 s24, 0
    v_mov_b32 v104, v4
    v_mov_b32 v105, v5
    v_mov_b32 v106, v6
    v_mov_b32 v107, v7
    s_mov_b32 s23, 16
    s_waitcnt lgkmcnt(0)
    s_barrier
    ds_read_b64_tr_b16 v[32:33], v106 offset:0
    ds_read_b64_tr_b16 v[34:35], v106 offset:1792
    ds_read_b128 v[16:19], v104 offset:0
    ds_read_b128 v[20:23], v104 offset:2048
    ds_read_b128 v[24:27], v104 offset:4096
    ds_read_b128 v[28:31], v104 offset:6144
    ds_read_b64_tr_b16 v[36:37], v107 offset:32
    ds_read_b64_tr_b16 v[38:39], v107 offset:1824
    ds_read_b64_tr_b16 v[40:41], v106 offset:64
    ds_read_b64_tr_b16 v[42:43], v106 offset:1856
    ds_read_b64_tr_b16 v[44:45], v107 offset:96
    ds_read_b64_tr_b16 v[46:47], v107 offset:1888
    ds_read_b64_tr_b16 v[48:49], v106 offset:128
    ds_read_b64_tr_b16 v[50:51], v106 offset:1920
    ds_read_b64_tr_b16 v[52:53], v107 offset:160
    ds_read_b64_tr_b16 v[54:55], v107 offset:1952
    ds_read_b64_tr_b16 v[56:57], v106 offset:192
    ds_read_b64_tr_b16 v[58:59], v106 offset:1984
    s_mov_b32 s23, 4
.p2align 6
f1_kernel_g1c0:
    s_waitcnt lgkmcnt(0)
    v_mfma_f32_16x16x32_bf16 v[128:131], v[32:35], v[16:19], v[128:131]
    ds_read_b64_tr_b16 v[76:77], v106 offset:14336
    v_mfma_f32_16x16x32_bf16 v[132:135], v[32:35], v[20:23], v[132:135]
    ds_read_b64_tr_b16 v[78:79], v106 offset:16128
    v_mfma_f32_16x16x32_bf16 v[136:139], v[32:35], v[24:27], v[136:139]
    ds_read_b128 v[60:63], v105 offset:0
    v_mfma_f32_16x16x32_bf16 v[140:143], v[32:35], v[28:31], v[140:143]
    ds_read_b128 v[64:67], v105 offset:2048
    s_waitcnt lgkmcnt(1)
    v_mfma_f32_16x16x32_bf16 v[144:147], v[36:39], v[16:19], v[144:147]
    ds_read_b128 v[68:71], v105 offset:4096
    v_mfma_f32_16x16x32_bf16 v[148:151], v[36:39], v[20:23], v[148:151]
    ds_read_b128 v[72:75], v105 offset:6144
    v_mfma_f32_16x16x32_bf16 v[152:155], v[36:39], v[24:27], v[152:155]
    ds_read_b64_tr_b16 v[80:81], v107 offset:14368
    v_mfma_f32_16x16x32_bf16 v[156:159], v[36:39], v[28:31], v[156:159]
    ds_read_b64_tr_b16 v[82:83], v107 offset:16160
    s_waitcnt lgkmcnt(1)
    v_mfma_f32_16x16x32_bf16 v[160:163], v[40:43], v[16:19], v[160:163]
    ds_read_b64_tr_b16 v[84:85], v106 offset:14400
    v_mfma_f32_16x16x32_bf16 v[164:167], v[40:43], v[20:23], v[164:167]
    ds_read_b64_tr_b16 v[86:87], v106 offset:16192
    v_mfma_f32_16x16x32_bf16 v[168:171], v[40:43], v[24:27], v[168:171]
    ds_read_b64_tr_b16 v[88:89], v107 offset:14432
    v_mfma_f32_16x16x32_bf16 v[172:175], v[40:43], v[28:31], v[172:175]
    ds_read_b64_tr_b16 v[90:91], v107 offset:16224
    s_waitcnt lgkmcnt(1)
    v_mfma_f32_16x16x32_bf16 v[176:179], v[44:47], v[16:19], v[176:179]
    ds_read_b64_tr_b16 v[92:93], v106 offset:14464
    v_mfma_f32_16x16x32_bf16 v[180:183], v[44:47], v[20:23], v[180:183]
    ds_read_b64_tr_b16 v[94:95], v106 offset:16256
    v_mfma_f32_16x16x32_bf16 v[184:187], v[44:47], v[24:27], v[184:187]
    ds_read_b64_tr_b16 v[96:97], v107 offset:14496
    v_mfma_f32_16x16x32_bf16 v[188:191], v[44:47], v[28:31], v[188:191]
    ds_read_b64_tr_b16 v[98:99], v107 offset:16288
    s_waitcnt lgkmcnt(1)
    v_mfma_f32_16x16x32_bf16 v[192:195], v[48:51], v[16:19], v[192:195]
    ds_read_b64_tr_b16 v[100:101], v106 offset:14528
    v_mfma_f32_16x16x32_bf16 v[196:199], v[48:51], v[20:23], v[196:199]
    ds_read_b64_tr_b16 v[102:103], v106 offset:16320
    v_mfma_f32_16x16x32_bf16 v[200:203], v[48:51], v[24:27], v[200:203]
    s_add_u32 s26, s26, 28672
    v_mfma_f32_16x16x32_bf16 v[204:207], v[48:51], v[28:31], v[204:207]
    s_add_u32 s24, s24, 16384
    s_waitcnt lgkmcnt(1)
    v_mfma_f32_16x16x32_bf16 v[208:211], v[52:55], v[16:19], v[208:211]
    s_cmp_eq_u32 s24, 49152
    v_mfma_f32_16x16x32_bf16 v[212:215], v[52:55], v[20:23], v[212:215]
    s_cselect_b32 s26, 0, s26
    v_mfma_f32_16x16x32_bf16 v[216:219], v[52:55], v[24:27], v[216:219]
    s_cselect_b32 s24, 0, s24
    v_mfma_f32_16x16x32_bf16 v[220:223], v[52:55], v[28:31], v[220:223]
    v_add_u32 v104, s24, v4
    v_mfma_f32_16x16x32_bf16 v[224:227], v[56:59], v[16:19], v[224:227]
    v_add_u32 v106, s26, v6
    v_mfma_f32_16x16x32_bf16 v[228:231], v[56:59], v[20:23], v[228:231]
    v_add_u32 v107, s26, v7
    v_mfma_f32_16x16x32_bf16 v[232:235], v[56:59], v[24:27], v[232:235]
    v_add_u32 v105, s24, v5
    v_mfma_f32_16x16x32_bf16 v[236:239], v[56:59], v[28:31], v[236:239]
    s_waitcnt lgkmcnt(0)
    s_barrier
    v_mfma_f32_16x16x32_bf16 v[128:131], v[76:79], v[60:63], v[128:131]
    ds_read_b64_tr_b16 v[32:33], v106 offset:0
    v_mfma_f32_16x16x32_bf16 v[132:135], v[76:79], v[64:67], v[132:135]
    ds_read_b64_tr_b16 v[34:35], v106 offset:1792
    v_mfma_f32_16x16x32_bf16 v[136:139], v[76:79], v[68:71], v[136:139]
    ds_read_b128 v[16:19], v104 offset:0
    v_mfma_f32_16x16x32_bf16 v[140:143], v[76:79], v[72:75], v[140:143]
    ds_read_b128 v[20:23], v104 offset:2048
    s_waitcnt lgkmcnt(1)
    v_mfma_f32_16x16x32_bf16 v[144:147], v[80:83], v[60:63], v[144:147]
    ds_read_b128 v[24:27], v104 offset:4096
    v_mfma_f32_16x16x32_bf16 v[148:151], v[80:83], v[64:67], v[148:151]
    ds_read_b128 v[28:31], v104 offset:6144
    v_mfma_f32_16x16x32_bf16 v[152:155], v[80:83], v[68:71], v[152:155]
    ds_read_b64_tr_b16 v[36:37], v107 offset:32
    v_mfma_f32_16x16x32_bf16 v[156:159], v[80:83], v[72:75], v[156:159]
    ds_read_b64_tr_b16 v[38:39], v107 offset:1824
    s_waitcnt lgkmcnt(1)
    v_mfma_f32_16x16x32_bf16 v[160:163], v[84:87], v[60:63], v[160:163]
    ds_read_b64_tr_b16 v[40:41], v106 offset:64
    v_mfma_f32_16x16x32_bf16 v[164:167], v[84:87], v[64:67], v[164:167]
    ds_read_b64_tr_b16 v[42:43], v106 offset:1856
    v_mfma_f32_16x16x32_bf16 v[168:171], v[84:87], v[68:71], v[168:171]
    ds_read_b64_tr_b16 v[44:45], v107 offset:96
    v_mfma_f32_16x16x32_bf16 v[172:175], v[84:87], v[72:75], v[172:175]
    ds_read_b64_tr_b16 v[46:47], v107 offset:1888
    s_waitcnt lgkmcnt(1)
    v_mfma_f32_16x16x32_bf16 v[176:179], v[88:91], v[60:63], v[176:179]
    ds_read_b64_tr_b16 v[48:49], v106 offset:128
    v_mfma_f32_16x16x32_bf16 v[180:183], v[88:91], v[64:67], v[180:183]
    ds_read_b64_tr_b16 v[50:51], v106 offset:1920
    v_mfma_f32_16x16x32_bf16 v[184:187], v[88:91], v[68:71], v[184:187]
    ds_read_b64_tr_b16 v[52:53], v107 offset:160
    v_mfma_f32_16x16x32_bf16 v[188:191], v[88:91], v[72:75], v[188:191]
    ds_read_b64_tr_b16 v[54:55], v107 offset:1952
    s_waitcnt lgkmcnt(1)
    v_mfma_f32_16x16x32_bf16 v[192:195], v[92:95], v[60:63], v[192:195]
    ds_read_b64_tr_b16 v[56:57], v106 offset:192
    v_mfma_f32_16x16x32_bf16 v[196:199], v[92:95], v[64:67], v[196:199]
    ds_read_b64_tr_b16 v[58:59], v106 offset:1984
    v_mfma_f32_16x16x32_bf16 v[200:203], v[92:95], v[68:71], v[200:203]
    s_sub_u32 s23, s23, 1
    v_mfma_f32_16x16x32_bf16 v[204:207], v[92:95], v[72:75], v[204:207]
    s_cmp_lg_u32 s23, 0
    s_waitcnt lgkmcnt(1)
    v_mfma_f32_16x16x32_bf16 v[208:211], v[96:99], v[60:63], v[208:211]
    v_mfma_f32_16x16x32_bf16 v[212:215], v[96:99], v[64:67], v[212:215]
    v_mfma_f32_16x16x32_bf16 v[216:219], v[96:99], v[68:71], v[216:219]
    v_mfma_f32_16x16x32_bf16 v[220:223], v[96:99], v[72:75], v[220:223]
    v_mfma_f32_16x16x32_bf16 v[224:227], v[100:103], v[60:63], v[224:227]
    v_mfma_f32_16x16x32_bf16 v[228:231], v[100:103], v[64:67], v[228:231]
    v_mfma_f32_16x16x32_bf16 v[232:235], v[100:103], v[68:71], v[232:235]
    v_mfma_f32_16x16x32_bf16 v[236:239], v[100:103], v[72:75], v[236:239]
    s_cbranch_scc1 f1_kernel_g1c0
    s_mov_b32 s23, 12
.p2align 6
f1_kernel_g1c:
    s_waitcnt lgkmcnt(0)
    v_mfma_f32_16x16x32_bf16 v[128:131], v[32:35], v[16:19], v[128:131]
    ds_read_b64_tr_b16 v[76:77], v106 offset:14336
    v_mfma_f32_16x16x32_bf16 v[132:135], v[32:35], v[20:23], v[132:135]
    ds_read_b64_tr_b16 v[78:79], v106 offset:16128
    v_mfma_f32_16x16x32_bf16 v[136:139], v[32:35], v[24:27], v[136:139]
    ds_read_b128 v[60:63], v105 offset:0
    v_mfma_f32_16x16x32_bf16 v[140:143], v[32:35], v[28:31], v[140:143]
    ds_read_b128 v[64:67], v105 offset:2048
    v_mfma_f32_16x16x32_bf16 v[144:147], v[36:39], v[16:19], v[144:147]
    ds_read_b128 v[68:71], v105 offset:4096
    v_mfma_f32_16x16x32_bf16 v[148:151], v[36:39], v[20:23], v[148:151]
    ds_read_b128 v[72:75], v105 offset:6144
    v_mfma_f32_16x16x32_bf16 v[152:155], v[36:39], v[24:27], v[152:155]
    ds_read_b64_tr_b16 v[80:81], v107 offset:14368
    v_mfma_f32_16x16x32_bf16 v[156:159], v[36:39], v[28:31], v[156:159]
    ds_read_b64_tr_b16 v[82:83], v107 offset:16160
    v_mfma_f32_16x16x32_bf16 v[160:163], v[40:43], v[16:19], v[160:163]
    ds_read_b64_tr_b16 v[84:85], v106 offset:14400
    v_mfma_f32_16x16x32_bf16 v[164:167], v[40:43], v[20:23], v[164:167]
    ds_read_b64_tr_b16 v[86:87], v106 offset:16192
    v_mfma_f32_16x16x32_bf16 v[168:171], v[40:43], v[24:27], v[168:171]
    ds_read_b64_tr_b16 v[88:89], v107 offset:14432
    v_mfma_f32_16x16x32_bf16 v[172:175], v[40:43], v[28:31], v[172:175]
    ds_read_b64_tr_b16 v[90:91], v107 offset:16224
    v_mfma_f32_16x16x32_bf16 v[176:179], v[44:47], v[16:19], v[176:179]
    ds_read_b64_tr_b16 v[92:93], v106 offset:14464
    v_mfma_f32_16x16x32_bf16 v[180:183], v[44:47], v[20:23], v[180:183]
    ds_read_b64_tr_b16 v[94:95], v106 offset:16256
    v_mfma_f32_16x16x32_bf16 v[184:187], v[44:47], v[24:27], v[184:187]
    ds_read_b64_tr_b16 v[96:97], v107 offset:14496
    v_mfma_f32_16x16x32_bf16 v[188:191], v[44:47], v[28:31], v[188:191]
    ds_read_b64_tr_b16 v[98:99], v107 offset:16288
    v_mfma_f32_16x16x32_bf16 v[192:195], v[48:51], v[16:19], v[192:195]
    ds_read_b64_tr_b16 v[100:101], v106 offset:14528
    v_mfma_f32_16x16x32_bf16 v[196:199], v[48:51], v[20:23], v[196:199]
    ds_read_b64_tr_b16 v[102:103], v106 offset:16320
    v_mfma_f32_16x16x32_bf16 v[200:203], v[48:51], v[24:27], v[200:203]
    s_add_u32 s26, s26, 28672
    v_mfma_f32_16x16x32_bf16 v[204:207], v[48:51], v[28:31], v[204:207]
    s_add_u32 s24, s24, 16384
    v_mfma_f32_16x16x32_bf16 v[208:211], v[52:55], v[16:19], v[208:211]
    s_cmp_eq_u32 s24, 49152
    v_mfma_f32_16x16x32_bf16 v[212:215], v[52:55], v[20:23], v[212:215]
    s_cselect_b32 s26, 0, s26
    v_mfma_f32_16x16x32_bf16 v[216:219], v[52:55], v[24:27], v[216:219]
    s_cselect_b32 s24, 0, s24
    v_mfma_f32_16x16x32_bf16 v[220:223], v[52:55], v[28:31], v[220:223]
    v_add_u32 v104, s24, v4
    v_mfma_f32_16x16x32_bf16 v[224:227], v[56:59], v[16:19], v[224:227]
    v_add_u32 v106, s26, v6
    v_mfma_f32_16x16x32_bf16 v[228:231], v[56:59], v[20:23], v[228:231]
    v_add_u32 v107, s26, v7
    v_mfma_f32_16x16x32_bf16 v[232:235], v[56:59], v[24:27], v[232:235]
    v_add_u32 v105, s24, v5
    v_mfma_f32_16x16x32_bf16 v[236:239], v[56:59], v[28:31], v[236:239]
    s_waitcnt lgkmcnt(0)
    s_barrier
    v_mfma_f32_16x16x32_bf16 v[128:131], v[76:79], v[60:63], v[128:131]
    ds_read_b64_tr_b16 v[32:33], v106 offset:0
    v_mfma_f32_16x16x32_bf16 v[132:135], v[76:79], v[64:67], v[132:135]
    ds_read_b64_tr_b16 v[34:35], v106 offset:1792
    v_mfma_f32_16x16x32_bf16 v[136:139], v[76:79], v[68:71], v[136:139]
    ds_read_b128 v[16:19], v104 offset:0
    v_mfma_f32_16x16x32_bf16 v[140:143], v[76:79], v[72:75], v[140:143]
    ds_read_b128 v[20:23], v104 offset:2048
    v_mfma_f32_16x16x32_bf16 v[144:147], v[80:83], v[60:63], v[144:147]
    ds_read_b128 v[24:27], v104 offset:4096
    v_mfma_f32_16x16x32_bf16 v[148:151], v[80:83], v[64:67], v[148:151]
    ds_read_b128 v[28:31], v104 offset:6144
    v_mfma_f32_16x16x32_bf16 v[152:155], v[80:83], v[68:71], v[152:155]
    ds_read_b64_tr_b16 v[36:37], v107 offset:32
    v_mfma_f32_16x16x32_bf16 v[156:159], v[80:83], v[72:75], v[156:159]
    ds_read_b64_tr_b16 v[38:39], v107 offset:1824
    v_mfma_f32_16x16x32_bf16 v[160:163], v[84:87], v[60:63], v[160:163]
    ds_read_b64_tr_b16 v[40:41], v106 offset:64
    v_mfma_f32_16x16x32_bf16 v[164:167], v[84:87], v[64:67], v[164:167]
    ds_read_b64_tr_b16 v[42:43], v106 offset:1856
    v_mfma_f32_16x16x32_bf16 v[168:171], v[84:87], v[68:71], v[168:171]
    ds_read_b64_tr_b16 v[44:45], v107 offset:96
    v_mfma_f32_16x16x32_bf16 v[172:175], v[84:87], v[72:75], v[172:175]
    ds_read_b64_tr_b16 v[46:47], v107 offset:1888
    v_mfma_f32_16x16x32_bf16 v[176:179], v[88:91], v[60:63], v[176:179]
    ds_read_b64_tr_b16 v[48:49], v106 offset:128
    v_mfma_f32_16x16x32_bf16 v[180:183], v[88:91], v[64:67], v[180:183]
    ds_read_b64_tr_b16 v[50:51], v106 offset:1920
    v_mfma_f32_16x16x32_bf16 v[184:187], v[88:91], v[68:71], v[184:187]
    ds_read_b64_tr_b16 v[52:53], v107 offset:160
    v_mfma_f32_16x16x32_bf16 v[188:191], v[88:91], v[72:75], v[188:191]
    ds_read_b64_tr_b16 v[54:55], v107 offset:1952
    v_mfma_f32_16x16x32_bf16 v[192:195], v[92:95], v[60:63], v[192:195]
    ds_read_b64_tr_b16 v[56:57], v106 offset:192
    v_mfma_f32_16x16x32_bf16 v[196:199], v[92:95], v[64:67], v[196:199]
    ds_read_b64_tr_b16 v[58:59], v106 offset:1984
    v_mfma_f32_16x16x32_bf16 v[200:203], v[92:95], v[68:71], v[200:203]
    s_sub_u32 s23, s23, 1
    v_mfma_f32_16x16x32_bf16 v[204:207], v[92:95], v[72:75], v[204:207]
    s_cmp_lg_u32 s23, 0
    v_mfma_f32_16x16x32_bf16 v[208:211], v[96:99], v[60:63], v[208:211]
    v_mfma_f32_16x16x32_bf16 v[212:215], v[96:99], v[64:67], v[212:215]
    v_mfma_f32_16x16x32_bf16 v[216:219], v[96:99], v[68:71], v[216:219]
    v_mfma_f32_16x16x32_bf16 v[220:223], v[96:99], v[72:75], v[220:223]
    v_mfma_f32_16x16x32_bf16 v[224:227], v[100:103], v[60:63], v[224:227]
    v_mfma_f32_16x16x32_bf16 v[228:231], v[100:103], v[64:67], v[228:231]
    v_mfma_f32_16x16x32_bf16 v[232:235], v[100:103], v[68:71], v[232:235]
    v_mfma_f32_16x16x32_bf16 v[236:239], v[100:103], v[72:75], v[236:239]
    s_cbranch_scc1 f1_kernel_g1c
    s_lshl_b32 s27, s21, 3
    s_lshl_b32 s30, s28, 2
    s_add_u32 s27, s27, s30
    s_mul_i32 s27, s27, 112
    s_mul_i32 s30, s22, 7
    s_add_u32 s27, s27, s30
    s_lshl_b32 s27, s27, 10
    v_and_b32 v13, 1, v12
    v_lshrrev_b32 v14, 1, v12
    v_lshl_or_b32 v13, v13, 1, v14
    v_lshlrev_b32 v108, 4, v13
    v_lshlrev_b32 v13, 8, v13
    v_lshl_add_u32 v13, v110, 4, v13
    v_lshlrev_b32 v14, 8, v14
    v_lshl_add_u32 v14, v110, 4, v14
    v_and_b32 v15, 1, v12
    v_mul_u32_u24 v15, 114688, v15
    v_add_u32 v14, v15, v14
    s_lshl_b32 s30, s28, 13
    s_add_u32 s30, s30, 65536
    v_add_u32 v10, s30, v13
    v_lshrrev_b32 v11, 1, v12
    v_lshlrev_b32 v11, 8, v11
    v_lshl_add_u32 v11, v110, 4, v11
    v_and_b32 v9, 1, v12
    v_lshl_add_u32 v11, v9, 11, v11
    v_add_u32 v11, s30, v11
    s_mov_b32 s32, 0xbfb8aa3b
    s_waitcnt lgkmcnt(0)
    v_add_u32 v15, 4096, v13
    s_cmp_eq_u32 s29, 0
    s_cbranch_scc0 f1_kernel_epi1
    s_add_u32 s30, s27, 0
    v_pk_mul_f32 v[40:41], v[128:129], s[32:33] op_sel_hi:[1,0]
    v_pk_mul_f32 v[42:43], v[130:131], s[32:33] op_sel_hi:[1,0]
    v_exp_f32 v40, v40
    v_exp_f32 v41, v41
    v_exp_f32 v42, v42
    v_exp_f32 v43, v43
    v_pk_add_f32 v[40:41], v[40:41], 1.0 op_sel_hi:[1,0]
    v_pk_add_f32 v[42:43], v[42:43], 1.0 op_sel_hi:[1,0]
    v_rcp_f32 v40, v40
    v_rcp_f32 v41, v41
    v_rcp_f32 v42, v42
    v_rcp_f32 v43, v43
    v_pk_mul_f32 v[40:41], v[40:41], v[128:129]
    v_pk_mul_f32 v[42:43], v[42:43], v[130:131]
    v_cvt_pk_bf16_f32 v16, v40, v41
    v_cvt_pk_bf16_f32 v17, v42, v43
    v_pk_mul_f32 v[44:45], v[144:145], s[32:33] op_sel_hi:[1,0]
    v_pk_mul_f32 v[46:47], v[146:147], s[32:33] op_sel_hi:[1,0]
    v_exp_f32 v44, v44
    v_exp_f32 v45, v45
    v_exp_f32 v46, v46
    v_exp_f32 v47, v47
    v_pk_add_f32 v[44:45], v[44:45], 1.0 op_sel_hi:[1,0]
    v_pk_add_f32 v[46:47], v[46:47], 1.0 op_sel_hi:[1,0]
    v_rcp_f32 v44, v44
    v_rcp_f32 v45, v45
    v_rcp_f32 v46, v46
    v_rcp_f32 v47, v47
    v_pk_mul_f32 v[44:45], v[44:45], v[144:145]
    v_pk_mul_f32 v[46:47], v[46:47], v[146:147]
    v_cvt_pk_bf16_f32 v18, v44, v45
    v_cvt_pk_bf16_f32 v19, v46, v47
    s_nop 1
    v_permlane16_swap_b32 v16, v18
    v_permlane16_swap_b32 v17, v19
    buffer_store_dwordx4 v[16:19], v13, s[16:19], s30 offen offset:0 sc0 sc1
    ds_write_b128 v10, v[16:19] offset:0
    v_pk_mul_f32 v[40:41], v[160:161], s[32:33] op_sel_hi:[1,0]
    v_pk_mul_f32 v[42:43], v[162:163], s[32:33] op_sel_hi:[1,0]
    v_exp_f32 v40, v40
    v_exp_f32 v41, v41
    v_exp_f32 v42, v42
    v_exp_f32 v43, v43
    v_pk_add_f32 v[40:41], v[40:41], 1.0 op_sel_hi:[1,0]
    v_pk_add_f32 v[42:43], v[42:43], 1.0 op_sel_hi:[1,0]
    v_rcp_f32 v40, v40
    v_rcp_f32 v41, v41
    v_rcp_f32 v42, v42
    v_rcp_f32 v43, v43
    v_pk_mul_f32 v[40:41], v[40:41], v[160:161]
    v_pk_mul_f32 v[42:43], v[42:43], v[162:163]
    v_cvt_pk_bf16_f32 v20, v40, v41
    v_cvt_pk_bf16_f32 v21, v42, v43
    v_pk_mul_f32 v[44:45], v[176:177], s[32:33] op_sel_hi:[1,0]
    v_pk_mul_f32 v[46:47], v[178:179], s[32:33] op_sel_hi:[1,0]
    v_exp_f32 v44, v44
    v_exp_f32 v45, v45
    v_exp_f32 v46, v46
    v_exp_f32 v47, v47
    v_pk_add_f32 v[44:45], v[44:45], 1.0 op_sel_hi:[1,0]
    v_pk_add_f32 v[46:47], v[46:47], 1.0 op_sel_hi:[1,0]
    v_rcp_f32 v44, v44
    v_rcp_f32 v45, v45
    v_rcp_f32 v46, v46
    v_rcp_f32 v47, v47
    v_pk_mul_f32 v[44:45], v[44:45], v[176:177]
    v_pk_mul_f32 v[46:47], v[46:47], v[178:179]
    v_cvt_pk_bf16_f32 v22, v44, v45
    v_cvt_pk_bf16_f32 v23, v46, v47
    s_nop 1
    v_permlane16_swap_b32 v20, v22
    v_permlane16_swap_b32 v21, v23
    buffer_store_dwordx4 v[20:23], v13, s[16:19], s30 offen offset:1024 sc0 sc1
    ds_write_b128 v10, v[20:23] offset:1024
    v_pk_mul_f32 v[40:41], v[192:193], s[32:33] op_sel_hi:[1,0]
    v_pk_mul_f32 v[42:43], v[194:195], s[32:33] op_sel_hi:[1,0]
    v_exp_f32 v40, v40
    v_exp_f32 v41, v41
    v_exp_f32 v42, v42
    v_exp_f32 v43, v43
    v_pk_add_f32 v[40:41], v[40:41], 1.0 op_sel_hi:[1,0]
    v_pk_add_f32 v[42:43], v[42:43], 1.0 op_sel_hi:[1,0]
    v_rcp_f32 v40, v40
    v_rcp_f32 v41, v41
    v_rcp_f32 v42, v42
    v_rcp_f32 v43, v43
    v_pk_mul_f32 v[40:41], v[40:41], v[192:193]
    v_pk_mul_f32 v[42:43], v[42:43], v[194:195]
    v_cvt_pk_bf16_f32 v24, v40, v41
    v_cvt_pk_bf16_f32 v25, v42, v43
    v_pk_mul_f32 v[44:45], v[208:209], s[32:33] op_sel_hi:[1,0]
    v_pk_mul_f32 v[46:47], v[210:211], s[32:33] op_sel_hi:[1,0]
    v_exp_f32 v44, v44
    v_exp_f32 v45, v45
    v_exp_f32 v46, v46
    v_exp_f32 v47, v47
    v_pk_add_f32 v[44:45], v[44:45], 1.0 op_sel_hi:[1,0]
    v_pk_add_f32 v[46:47], v[46:47], 1.0 op_sel_hi:[1,0]
    v_rcp_f32 v44, v44
    v_rcp_f32 v45, v45
    v_rcp_f32 v46, v46
    v_rcp_f32 v47, v47
    v_pk_mul_f32 v[44:45], v[44:45], v[208:209]
    v_pk_mul_f32 v[46:47], v[46:47], v[210:211]
    v_cvt_pk_bf16_f32 v26, v44, v45
    v_cvt_pk_bf16_f32 v27, v46, v47
    s_nop 1
    v_permlane16_swap_b32 v24, v26
    v_permlane16_swap_b32 v25, v27
    buffer_store_dwordx4 v[24:27], v13, s[16:19], s30 offen offset:2048 sc0 sc1
    ds_write_b128 v10, v[24:27] offset:16384
    v_pk_mul_f32 v[40:41], v[224:225], s[32:33] op_sel_hi:[1,0]
    v_pk_mul_f32 v[42:43], v[226:227], s[32:33] op_sel_hi:[1,0]
    v_exp_f32 v40, v40
    v_exp_f32 v41, v41
    v_exp_f32 v42, v42
    v_exp_f32 v43, v43
    v_pk_add_f32 v[40:41], v[40:41], 1.0 op_sel_hi:[1,0]
    v_pk_add_f32 v[42:43], v[42:43], 1.0 op_sel_hi:[1,0]
    v_rcp_f32 v40, v40
    v_rcp_f32 v41, v41
    v_rcp_f32 v42, v42
    v_rcp_f32 v43, v43
    v_pk_mul_f32 v[40:41], v[40:41], v[224:225]
    v_pk_mul_f32 v[42:43], v[42:43], v[226:227]
    v_cvt_pk_bf16_f32 v32, v40, v41
    v_cvt_pk_bf16_f32 v33, v42, v43
    v_pk_mul_f32 v[44:45], v[228:229], s[32:33] op_sel_hi:[1,0]
    v_pk_mul_f32 v[46:47], v[230:231], s[32:33] op_sel_hi:[1,0]
    v_exp_f32 v44, v44
    v_exp_f32 v45, v45
    v_exp_f32 v46, v46
    v_exp_f32 v47, v47
    v_pk_add_f32 v[44:45], v[44:45], 1.0 op_sel_hi:[1,0]
    v_pk_add_f32 v[46:47], v[46:47], 1.0 op_sel_hi:[1,0]
    v_rcp_f32 v44, v44
    v_rcp_f32 v45, v45
    v_rcp_f32 v46, v46
    v_rcp_f32 v47, v47
    v_pk_mul_f32 v[44:45], v[44:45], v[228:229]
    v_pk_mul_f32 v[46:47], v[46:47], v[230:231]
    v_cvt_pk_bf16_f32 v34, v44, v45
    v_cvt_pk_bf16_f32 v35, v46, v47
    s_nop 1
    v_permlane16_swap_b32 v32, v34
    v_permlane16_swap_b32 v33, v35
    buffer_store_dwordx4 v[32:35], v14, s[16:19], s30 offen offset:3072 sc0 sc1
    ds_write_b128 v11, v[32:35] offset:17408
    s_add_u32 s30, s27, 114688
    v_pk_mul_f32 v[40:41], v[132:133], s[32:33] op_sel_hi:[1,0]
    v_pk_mul_f32 v[42:43], v[134:135], s[32:33] op_sel_hi:[1,0]
    v_exp_f32 v40, v40
    v_exp_f32 v41, v41
    v_exp_f32 v42, v42
    v_exp_f32 v43, v43
    v_pk_add_f32 v[40:41], v[40:41], 1.0 op_sel_hi:[1,0]
    v_pk_add_f32 v[42:43], v[42:43], 1.0 op_sel_hi:[1,0]
    v_rcp_f32 v40, v40
    v_rcp_f32 v41, v41
    v_rcp_f32 v42, v42
    v_rcp_f32 v43, v43
    v_pk_mul_f32 v[40:41], v[40:41], v[132:133]
    v_pk_mul_f32 v[42:43], v[42:43], v[134:135]
    v_cvt_pk_bf16_f32 v28, v40, v41
    v_cvt_pk_bf16_f32 v29, v42, v43
    v_pk_mul_f32 v[44:45], v[148:149], s[32:33] op_sel_hi:[1,0]
    v_pk_mul_f32 v[46:47], v[150:151], s[32:33] op_sel_hi:[1,0]
    v_exp_f32 v44, v44
    v_exp_f32 v45, v45
    v_exp_f32 v46, v46
    v_exp_f32 v47, v47
    v_pk_add_f32 v[44:45], v[44:45], 1.0 op_sel_hi:[1,0]
    v_pk_add_f32 v[46:47], v[46:47], 1.0 op_sel_hi:[1,0]
    v_rcp_f32 v44, v44
    v_rcp_f32 v45, v45
    v_rcp_f32 v46, v46
    v_rcp_f32 v47, v47
    v_pk_mul_f32 v[44:45], v[44:45], v[148:149]
    v_pk_mul_f32 v[46:47], v[46:47], v[150:151]
    v_cvt_pk_bf16_f32 v30, v44, v45
    v_cvt_pk_bf16_f32 v31, v46, v47
    s_nop 1
    v_permlane16_swap_b32 v28, v30
    v_permlane16_swap_b32 v29, v31
    buffer_store_dwordx4 v[28:31], v13, s[16:19], s30 offen offset:0 sc0 sc1
    ds_write_b128 v10, v[28:31] offset:2048
    v_pk_mul_f32 v[40:41], v[164:165], s[32:33] op_sel_hi:[1,0]
    v_pk_mul_f32 v[42:43], v[166:167], s[32:33] op_sel_hi:[1,0]
    v_exp_f32 v40, v40
    v_exp_f32 v41, v41
    v_exp_f32 v42, v42
    v_exp_f32 v43, v43
    v_pk_add_f32 v[40:41], v[40:41], 1.0 op_sel_hi:[1,0]
    v_pk_add_f32 v[42:43], v[42:43], 1.0 op_sel_hi:[1,0]
    v_rcp_f32 v40, v40
    v_rcp_f32 v41, v41
    v_rcp_f32 v42, v42
    v_rcp_f32 v43, v43
    v_pk_mul_f32 v[40:41], v[40:41], v[164:165]
    v_pk_mul_f32 v[42:43], v[42:43], v[166:167]
    v_cvt_pk_bf16_f32 v16, v40, v41
    v_cvt_pk_bf16_f32 v17, v42, v43
    v_pk_mul_f32 v[44:45], v[180:181], s[32:33] op_sel_hi:[1,0]
    v_pk_mul_f32 v[46:47], v[182:183], s[32:33] op_sel_hi:[1,0]
    v_exp_f32 v44, v44
    v_exp_f32 v45, v45
    v_exp_f32 v46, v46
    v_exp_f32 v47, v47
    v_pk_add_f32 v[44:45], v[44:45], 1.0 op_sel_hi:[1,0]
    v_pk_add_f32 v[46:47], v[46:47], 1.0 op_sel_hi:[1,0]
    v_rcp_f32 v44, v44
    v_rcp_f32 v45, v45
    v_rcp_f32 v46, v46
    v_rcp_f32 v47, v47
    v_pk_mul_f32 v[44:45], v[44:45], v[180:181]
    v_pk_mul_f32 v[46:47], v[46:47], v[182:183]
    v_cvt_pk_bf16_f32 v18, v44, v45
    v_cvt_pk_bf16_f32 v19, v46, v47
    s_nop 1
    v_permlane16_swap_b32 v16, v18
    v_permlane16_swap_b32 v17, v19
    buffer_store_dwordx4 v[16:19], v13, s[16:19], s30 offen offset:1024 sc0 sc1
    ds_write_b128 v10, v[16:19] offset:3072
    v_pk_mul_f32 v[40:41], v[196:197], s[32:33] op_sel_hi:[1,0]
    v_pk_mul_f32 v[42:43], v[198:199], s[32:33] op_sel_hi:[1,0]
    v_exp_f32 v40, v40
    v_exp_f32 v41, v41
    v_exp_f32 v42, v42
    v_exp_f32 v43, v43
    v_pk_add_f32 v[40:41], v[40:41], 1.0 op_sel_hi:[1,0]
    v_pk_add_f32 v[42:43], v[42:43], 1.0 op_sel_hi:[1,0]
    v_rcp_f32 v40, v40
    v_rcp_f32 v41, v41
    v_rcp_f32 v42, v42
    v_rcp_f32 v43, v43
    v_pk_mul_f32 v[40:41], v[40:41], v[196:197]
    v_pk_mul_f32 v[42:43], v[42:43], v[198:199]
    v_cvt_pk_bf16_f32 v20, v40, v41
    v_cvt_pk_bf16_f32 v21, v42, v43
    v_pk_mul_f32 v[44:45], v[212:213], s[32:33] op_sel_hi:[1,0]
    v_pk_mul_f32 v[46:47], v[214:215], s[32:33] op_sel_hi:[1,0]
    v_exp_f32 v44, v44
    v_exp_f32 v45, v45
    v_exp_f32 v46, v46
    v_exp_f32 v47, v47
    v_pk_add_f32 v[44:45], v[44:45], 1.0 op_sel_hi:[1,0]
    v_pk_add_f32 v[46:47], v[46:47], 1.0 op_sel_hi:[1,0]
    v_rcp_f32 v44, v44
    v_rcp_f32 v45, v45
    v_rcp_f32 v46, v46
    v_rcp_f32 v47, v47
    v_pk_mul_f32 v[44:45], v[44:45], v[212:213]
    v_pk_mul_f32 v[46:47], v[46:47], v[214:215]
    v_cvt_pk_bf16_f32 v22, v44, v45
    v_cvt_pk_bf16_f32 v23, v46, v47
    s_nop 1
    v_permlane16_swap_b32 v20, v22
    v_permlane16_swap_b32 v21, v23
    buffer_store_dwordx4 v[20:23], v13, s[16:19], s30 offen offset:2048 sc0 sc1
    ds_write_b128 v10, v[20:23] offset:18432
    s_add_u32 s30, s27, 229376
    v_pk_mul_f32 v[40:41], v[136:137], s[32:33] op_sel_hi:[1,0]
    v_pk_mul_f32 v[42:43], v[138:139], s[32:33] op_sel_hi:[1,0]
    v_exp_f32 v40, v40
    v_exp_f32 v41, v41
    v_exp_f32 v42, v42
    v_exp_f32 v43, v43
    v_pk_add_f32 v[40:41], v[40:41], 1.0 op_sel_hi:[1,0]
    v_pk_add_f32 v[42:43], v[42:43], 1.0 op_sel_hi:[1,0]
    v_rcp_f32 v40, v40
    v_rcp_f32 v41, v41
    v_rcp_f32 v42, v42
    v_rcp_f32 v43, v43
    v_pk_mul_f32 v[40:41], v[40:41], v[136:137]
    v_pk_mul_f32 v[42:43], v[42:43], v[138:139]
    v_cvt_pk_bf16_f32 v24, v40, v41
    v_cvt_pk_bf16_f32 v25, v42, v43
    v_pk_mul_f32 v[44:45], v[152:153], s[32:33] op_sel_hi:[1,0]
    v_pk_mul_f32 v[46:47], v[154:155], s[32:33] op_sel_hi:[1,0]
    v_exp_f32 v44, v44
    v_exp_f32 v45, v45
    v_exp_f32 v46, v46
    v_exp_f32 v47, v47
    v_pk_add_f32 v[44:45], v[44:45], 1.0 op_sel_hi:[1,0]
    v_pk_add_f32 v[46:47], v[46:47], 1.0 op_sel_hi:[1,0]
    v_rcp_f32 v44, v44
    v_rcp_f32 v45, v45
    v_rcp_f32 v46, v46
    v_rcp_f32 v47, v47
    v_pk_mul_f32 v[44:45], v[44:45], v[152:153]
    v_pk_mul_f32 v[46:47], v[46:47], v[154:155]
    v_cvt_pk_bf16_f32 v26, v44, v45
    v_cvt_pk_bf16_f32 v27, v46, v47
    s_nop 1
    v_permlane16_swap_b32 v24, v26
    v_permlane16_swap_b32 v25, v27
    buffer_store_dwordx4 v[24:27], v13, s[16:19], s30 offen offset:0 sc0 sc1
    ds_write_b128 v10, v[24:27] offset:4096
    v_pk_mul_f32 v[40:41], v[168:169], s[32:33] op_sel_hi:[1,0]
    v_pk_mul_f32 v[42:43], v[170:171], s[32:33] op_sel_hi:[1,0]
    v_exp_f32 v40, v40
    v_exp_f32 v41, v41
    v_exp_f32 v42, v42
    v_exp_f32 v43, v43
    v_pk_add_f32 v[40:41], v[40:41], 1.0 op_sel_hi:[1,0]
    v_pk_add_f32 v[42:43], v[42:43], 1.0 op_sel_hi:[1,0]
    v_rcp_f32 v40, v40
    v_rcp_f32 v41, v41
    v_rcp_f32 v42, v42
    v_rcp_f32 v43, v43
    v_pk_mul_f32 v[40:41], v[40:41], v[168:169]
    v_pk_mul_f32 v[42:43], v[42:43], v[170:171]
    v_cvt_pk_bf16_f32 v28, v40, v41
    v_cvt_pk_bf16_f32 v29, v42, v43
    v_pk_mul_f32 v[44:45], v[184:185], s[32:33] op_sel_hi:[1,0]
    v_pk_mul_f32 v[46:47], v[186:187], s[32:33] op_sel_hi:[1,0]
    v_exp_f32 v44, v44
    v_exp_f32 v45, v45
    v_exp_f32 v46, v46
    v_exp_f32 v47, v47
    v_pk_add_f32 v[44:45], v[44:45], 1.0 op_sel_hi:[1,0]
    v_pk_add_f32 v[46:47], v[46:47], 1.0 op_sel_hi:[1,0]
    v_rcp_f32 v44, v44
    v_rcp_f32 v45, v45
    v_rcp_f32 v46, v46
    v_rcp_f32 v47, v47
    v_pk_mul_f32 v[44:45], v[44:45], v[184:185]
    v_pk_mul_f32 v[46:47], v[46:47], v[186:187]
    v_cvt_pk_bf16_f32 v30, v44, v45
    v_cvt_pk_bf16_f32 v31, v46, v47
    s_nop 1
    v_permlane16_swap_b32 v28, v30
    v_permlane16_swap_b32 v29, v31
    buffer_store_dwordx4 v[28:31], v13, s[16:19], s30 offen offset:1024 sc0 sc1
    ds_write_b128 v10, v[28:31] offset:5120
    v_pk_mul_f32 v[40:41], v[200:201], s[32:33] op_sel_hi:[1,0]
    v_pk_mul_f32 v[42:43], v[202:203], s[32:33] op_sel_hi:[1,0]
    v_exp_f32 v40, v40
    v_exp_f32 v41, v41
    v_exp_f32 v42, v42
    v_exp_f32 v43, v43
    v_pk_add_f32 v[40:41], v[40:41], 1.0 op_sel_hi:[1,0]
    v_pk_add_f32 v[42:43], v[42:43], 1.0 op_sel_hi:[1,0]
    v_rcp_f32 v40, v40
    v_rcp_f32 v41, v41
    v_rcp_f32 v42, v42
    v_rcp_f32 v43, v43
    v_pk_mul_f32 v[40:41], v[40:41], v[200:201]
    v_pk_mul_f32 v[42:43], v[42:43], v[202:203]
    v_cvt_pk_bf16_f32 v16, v40, v41
    v_cvt_pk_bf16_f32 v17, v42, v43
    v_pk_mul_f32 v[44:45], v[216:217], s[32:33] op_sel_hi:[1,0]
    v_pk_mul_f32 v[46:47], v[218:219], s[32:33] op_sel_hi:[1,0]
    v_exp_f32 v44, v44
    v_exp_f32 v45, v45
    v_exp_f32 v46, v46
    v_exp_f32 v47, v47
    v_pk_add_f32 v[44:45], v[44:45], 1.0 op_sel_hi:[1,0]
    v_pk_add_f32 v[46:47], v[46:47], 1.0 op_sel_hi:[1,0]
    v_rcp_f32 v44, v44
    v_rcp_f32 v45, v45
    v_rcp_f32 v46, v46
    v_rcp_f32 v47, v47
    v_pk_mul_f32 v[44:45], v[44:45], v[216:217]
    v_pk_mul_f32 v[46:47], v[46:47], v[218:219]
    v_cvt_pk_bf16_f32 v18, v44, v45
    v_cvt_pk_bf16_f32 v19, v46, v47
    s_nop 1
    v_permlane16_swap_b32 v16, v18
    v_permlane16_swap_b32 v17, v19
    buffer_store_dwordx4 v[16:19], v13, s[16:19], s30 offen offset:2048 sc0 sc1
    ds_write_b128 v10, v[16:19] offset:20480
    v_pk_mul_f32 v[40:41], v[232:233], s[32:33] op_sel_hi:[1,0]
    v_pk_mul_f32 v[42:43], v[234:235], s[32:33] op_sel_hi:[1,0]
    v_exp_f32 v40, v40
    v_exp_f32 v41, v41
    v_exp_f32 v42, v42
    v_exp_f32 v43, v43
    v_pk_add_f32 v[40:41], v[40:41], 1.0 op_sel_hi:[1,0]
    v_pk_add_f32 v[42:43], v[42:43], 1.0 op_sel_hi:[1,0]
    v_rcp_f32 v40, v40
    v_rcp_f32 v41, v41
    v_rcp_f32 v42, v42
    v_rcp_f32 v43, v43
    v_pk_mul_f32 v[40:41], v[40:41], v[232:233]
    v_pk_mul_f32 v[42:43], v[42:43], v[234:235]
    v_cvt_pk_bf16_f32 v36, v40, v41
    v_cvt_pk_bf16_f32 v37, v42, v43
    v_pk_mul_f32 v[44:45], v[236:237], s[32:33] op_sel_hi:[1,0]
    v_pk_mul_f32 v[46:47], v[238:239], s[32:33] op_sel_hi:[1,0]
    v_exp_f32 v44, v44
    v_exp_f32 v45, v45
    v_exp_f32 v46, v46
    v_exp_f32 v47, v47
    v_pk_add_f32 v[44:45], v[44:45], 1.0 op_sel_hi:[1,0]
    v_pk_add_f32 v[46:47], v[46:47], 1.0 op_sel_hi:[1,0]
    v_rcp_f32 v44, v44
    v_rcp_f32 v45, v45
    v_rcp_f32 v46, v46
    v_rcp_f32 v47, v47
    v_pk_mul_f32 v[44:45], v[44:45], v[236:237]
    v_pk_mul_f32 v[46:47], v[46:47], v[238:239]
    v_cvt_pk_bf16_f32 v38, v44, v45
    v_cvt_pk_bf16_f32 v39, v46, v47
    s_nop 1
    v_permlane16_swap_b32 v36, v38
    v_permlane16_swap_b32 v37, v39
    buffer_store_dwordx4 v[36:39], v14, s[16:19], s30 offen offset:3072 sc0 sc1
    ds_write_b128 v11, v[36:39] offset:21504
    s_add_u32 s30, s27, 344064
    v_pk_mul_f32 v[40:41], v[140:141], s[32:33] op_sel_hi:[1,0]
    v_pk_mul_f32 v[42:43], v[142:143], s[32:33] op_sel_hi:[1,0]
    v_exp_f32 v40, v40
    v_exp_f32 v41, v41
    v_exp_f32 v42, v42
    v_exp_f32 v43, v43
    v_pk_add_f32 v[40:41], v[40:41], 1.0 op_sel_hi:[1,0]
    v_pk_add_f32 v[42:43], v[42:43], 1.0 op_sel_hi:[1,0]
    v_rcp_f32 v40, v40
    v_rcp_f32 v41, v41
    v_rcp_f32 v42, v42
    v_rcp_f32 v43, v43
    v_pk_mul_f32 v[40:41], v[40:41], v[140:141]
    v_pk_mul_f32 v[42:43], v[42:43], v[142:143]
    v_cvt_pk_bf16_f32 v20, v40, v41
    v_cvt_pk_bf16_f32 v21, v42, v43
    v_pk_mul_f32 v[44:45], v[156:157], s[32:33] op_sel_hi:[1,0]
    v_pk_mul_f32 v[46:47], v[158:159], s[32:33] op_sel_hi:[1,0]
    v_exp_f32 v44, v44
    v_exp_f32 v45, v45
    v_exp_f32 v46, v46
    v_exp_f32 v47, v47
    v_pk_add_f32 v[44:45], v[44:45], 1.0 op_sel_hi:[1,0]
    v_pk_add_f32 v[46:47], v[46:47], 1.0 op_sel_hi:[1,0]
    v_rcp_f32 v44, v44
    v_rcp_f32 v45, v45
    v_rcp_f32 v46, v46
    v_rcp_f32 v47, v47
    v_pk_mul_f32 v[44:45], v[44:45], v[156:157]
    v_pk_mul_f32 v[46:47], v[46:47], v[158:159]
    v_cvt_pk_bf16_f32 v22, v44, v45
    v_cvt_pk_bf16_f32 v23, v46, v47
    s_nop 1
    v_permlane16_swap_b32 v20, v22
    v_permlane16_swap_b32 v21, v23
    buffer_store_dwordx4 v[20:23], v13, s[16:19], s30 offen offset:0 sc0 sc1
    ds_write_b128 v10, v[20:23] offset:6144
    v_pk_mul_f32 v[40:41], v[172:173], s[32:33] op_sel_hi:[1,0]
    v_pk_mul_f32 v[42:43], v[174:175], s[32:33] op_sel_hi:[1,0]
    v_exp_f32 v40, v40
    v_exp_f32 v41, v41
    v_exp_f32 v42, v42
    v_exp_f32 v43, v43
    v_pk_add_f32 v[40:41], v[40:41], 1.0 op_sel_hi:[1,0]
    v_pk_add_f32 v[42:43], v[42:43], 1.0 op_sel_hi:[1,0]
    v_rcp_f32 v40, v40
    v_rcp_f32 v41, v41
    v_rcp_f32 v42, v42
    v_rcp_f32 v43, v43
    v_pk_mul_f32 v[40:41], v[40:41], v[172:173]
    v_pk_mul_f32 v[42:43], v[42:43], v[174:175]
    v_cvt_pk_bf16_f32 v24, v40, v41
    v_cvt_pk_bf16_f32 v25, v42, v43
    v_pk_mul_f32 v[44:45], v[188:189], s[32:33] op_sel_hi:[1,0]
    v_pk_mul_f32 v[46:47], v[190:191], s[32:33] op_sel_hi:[1,0]
    v_exp_f32 v44, v44
    v_exp_f32 v45, v45
    v_exp_f32 v46, v46
    v_exp_f32 v47, v47
    v_pk_add_f32 v[44:45], v[44:45], 1.0 op_sel_hi:[1,0]
    v_pk_add_f32 v[46:47], v[46:47], 1.0 op_sel_hi:[1,0]
    v_rcp_f32 v44, v44
    v_rcp_f32 v45, v45
    v_rcp_f32 v46, v46
    v_rcp_f32 v47, v47
    v_pk_mul_f32 v[44:45], v[44:45], v[188:189]
    v_pk_mul_f32 v[46:47], v[46:47], v[190:191]
    v_cvt_pk_bf16_f32 v26, v44, v45
    v_cvt_pk_bf16_f32 v27, v46, v47
    s_nop 1
    v_permlane16_swap_b32 v24, v26
    v_permlane16_swap_b32 v25, v27
    buffer_store_dwordx4 v[24:27], v13, s[16:19], s30 offen offset:1024 sc0 sc1
    ds_write_b128 v10, v[24:27] offset:7168
    v_pk_mul_f32 v[40:41], v[204:205], s[32:33] op_sel_hi:[1,0]
    v_pk_mul_f32 v[42:43], v[206:207], s[32:33] op_sel_hi:[1,0]
    v_exp_f32 v40, v40
    v_exp_f32 v41, v41
    v_exp_f32 v42, v42
    v_exp_f32 v43, v43
    v_pk_add_f32 v[40:41], v[40:41], 1.0 op_sel_hi:[1,0]
    v_pk_add_f32 v[42:43], v[42:43], 1.0 op_sel_hi:[1,0]
    v_rcp_f32 v40, v40
    v_rcp_f32 v41, v41
    v_rcp_f32 v42, v42
    v_rcp_f32 v43, v43
    v_pk_mul_f32 v[40:41], v[40:41], v[204:205]
    v_pk_mul_f32 v[42:43], v[42:43], v[206:207]
    v_cvt_pk_bf16_f32 v28, v40, v41
    v_cvt_pk_bf16_f32 v29, v42, v43
    v_pk_mul_f32 v[44:45], v[220:221], s[32:33] op_sel_hi:[1,0]
    v_pk_mul_f32 v[46:47], v[222:223], s[32:33] op_sel_hi:[1,0]
    v_exp_f32 v44, v44
    v_exp_f32 v45, v45
    v_exp_f32 v46, v46
    v_exp_f32 v47, v47
    v_pk_add_f32 v[44:45], v[44:45], 1.0 op_sel_hi:[1,0]
    v_pk_add_f32 v[46:47], v[46:47], 1.0 op_sel_hi:[1,0]
    v_rcp_f32 v44, v44
    v_rcp_f32 v45, v45
    v_rcp_f32 v46, v46
    v_rcp_f32 v47, v47
    v_pk_mul_f32 v[44:45], v[44:45], v[220:221]
    v_pk_mul_f32 v[46:47], v[46:47], v[222:223]
    v_cvt_pk_bf16_f32 v30, v44, v45
    v_cvt_pk_bf16_f32 v31, v46, v47
    s_nop 1
    v_permlane16_swap_b32 v28, v30
    v_permlane16_swap_b32 v29, v31
    buffer_store_dwordx4 v[28:31], v13, s[16:19], s30 offen offset:2048 sc0 sc1
    ds_write_b128 v10, v[28:31] offset:22528
    s_branch f1_kernel_epi2
f1_kernel_epi1:
    s_add_u32 s30, s27, 0
    v_pk_mul_f32 v[40:41], v[144:145], s[32:33] op_sel_hi:[1,0]
    v_pk_mul_f32 v[42:43], v[146:147], s[32:33] op_sel_hi:[1,0]
    v_exp_f32 v40, v40
    v_exp_f32 v41, v41
    v_exp_f32 v42, v42
    v_exp_f32 v43, v43
    v_pk_add_f32 v[40:41], v[40:41], 1.0 op_sel_hi:[1,0]
    v_pk_add_f32 v[42:43], v[42:43], 1.0 op_sel_hi:[1,0]
    v_rcp_f32 v40, v40
    v_rcp_f32 v41, v41
    v_rcp_f32 v42, v42
    v_rcp_f32 v43, v43
    v_pk_mul_f32 v[40:41], v[40:41], v[144:145]
    v_pk_mul_f32 v[42:43], v[42:43], v[146:147]
    v_cvt_pk_bf16_f32 v16, v40, v41
    v_cvt_pk_bf16_f32 v17, v42, v43
    v_pk_mul_f32 v[44:45], v[160:161], s[32:33] op_sel_hi:[1,0]
    v_pk_mul_f32 v[46:47], v[162:163], s[32:33] op_sel_hi:[1,0]
    v_exp_f32 v44, v44
    v_exp_f32 v45, v45
    v_exp_f32 v46, v46
    v_exp_f32 v47, v47
    v_pk_add_f32 v[44:45], v[44:45], 1.0 op_sel_hi:[1,0]
    v_pk_add_f32 v[46:47], v[46:47], 1.0 op_sel_hi:[1,0]
    v_rcp_f32 v44, v44
    v_rcp_f32 v45, v45
    v_rcp_f32 v46, v46
    v_rcp_f32 v47, v47
    v_pk_mul_f32 v[44:45], v[44:45], v[160:161]
    v_pk_mul_f32 v[46:47], v[46:47], v[162:163]
    v_cvt_pk_bf16_f32 v18, v44, v45
    v_cvt_pk_bf16_f32 v19, v46, v47
    s_nop 1
    v_permlane16_swap_b32 v16, v18
    v_permlane16_swap_b32 v17, v19
    buffer_store_dwordx4 v[16:19], v15, s[16:19], s30 offen offset:0 sc0 sc1
    ds_write_b128 v10, v[16:19] offset:32768
    v_pk_mul_f32 v[40:41], v[176:177], s[32:33] op_sel_hi:[1,0]
    v_pk_mul_f32 v[42:43], v[178:179], s[32:33] op_sel_hi:[1,0]
    v_exp_f32 v40, v40
    v_exp_f32 v41, v41
    v_exp_f32 v42, v42
    v_exp_f32 v43, v43
    v_pk_add_f32 v[40:41], v[40:41], 1.0 op_sel_hi:[1,0]
    v_pk_add_f32 v[42:43], v[42:43], 1.0 op_sel_hi:[1,0]
    v_rcp_f32 v40, v40
    v_rcp_f32 v41, v41
    v_rcp_f32 v42, v42
    v_rcp_f32 v43, v43
    v_pk_mul_f32 v[40:41], v[40:41], v[176:177]
    v_pk_mul_f32 v[42:43], v[42:43], v[178:179]
    v_cvt_pk_bf16_f32 v20, v40, v41
    v_cvt_pk_bf16_f32 v21, v42, v43
    v_pk_mul_f32 v[44:45], v[192:193], s[32:33] op_sel_hi:[1,0]
    v_pk_mul_f32 v[46:47], v[194:195], s[32:33] op_sel_hi:[1,0]
    v_exp_f32 v44, v44
    v_exp_f32 v45, v45
    v_exp_f32 v46, v46
    v_exp_f32 v47, v47
    v_pk_add_f32 v[44:45], v[44:45], 1.0 op_sel_hi:[1,0]
    v_pk_add_f32 v[46:47], v[46:47], 1.0 op_sel_hi:[1,0]
    v_rcp_f32 v44, v44
    v_rcp_f32 v45, v45
    v_rcp_f32 v46, v46
    v_rcp_f32 v47, v47
    v_pk_mul_f32 v[44:45], v[44:45], v[192:193]
    v_pk_mul_f32 v[46:47], v[46:47], v[194:195]
    v_cvt_pk_bf16_f32 v22, v44, v45
    v_cvt_pk_bf16_f32 v23, v46, v47
    s_nop 1
    v_permlane16_swap_b32 v20, v22
    v_permlane16_swap_b32 v21, v23
    buffer_store_dwordx4 v[20:23], v15, s[16:19], s30 offen offset:1024 sc0 sc1
    ds_write_b128 v10, v[20:23] offset:33792
    v_pk_mul_f32 v[40:41], v[208:209], s[32:33] op_sel_hi:[1,0]
    v_pk_mul_f32 v[42:43], v[210:211], s[32:33] op_sel_hi:[1,0]
    v_exp_f32 v40, v40
    v_exp_f32 v41, v41
    v_exp_f32 v42, v42
    v_exp_f32 v43, v43
    v_pk_add_f32 v[40:41], v[40:41], 1.0 op_sel_hi:[1,0]
    v_pk_add_f32 v[42:43], v[42:43], 1.0 op_sel_hi:[1,0]
    v_rcp_f32 v40, v40
    v_rcp_f32 v41, v41
    v_rcp_f32 v42, v42
    v_rcp_f32 v43, v43
    v_pk_mul_f32 v[40:41], v[40:41], v[208:209]
    v_pk_mul_f32 v[42:43], v[42:43], v[210:211]
    v_cvt_pk_bf16_f32 v24, v40, v41
    v_cvt_pk_bf16_f32 v25, v42, v43
    v_pk_mul_f32 v[44:45], v[224:225], s[32:33] op_sel_hi:[1,0]
    v_pk_mul_f32 v[46:47], v[226:227], s[32:33] op_sel_hi:[1,0]
    v_exp_f32 v44, v44
    v_exp_f32 v45, v45
    v_exp_f32 v46, v46
    v_exp_f32 v47, v47
    v_pk_add_f32 v[44:45], v[44:45], 1.0 op_sel_hi:[1,0]
    v_pk_add_f32 v[46:47], v[46:47], 1.0 op_sel_hi:[1,0]
    v_rcp_f32 v44, v44
    v_rcp_f32 v45, v45
    v_rcp_f32 v46, v46
    v_rcp_f32 v47, v47
    v_pk_mul_f32 v[44:45], v[44:45], v[224:225]
    v_pk_mul_f32 v[46:47], v[46:47], v[226:227]
    v_cvt_pk_bf16_f32 v26, v44, v45
    v_cvt_pk_bf16_f32 v27, v46, v47
    s_nop 1
    v_permlane16_swap_b32 v24, v26
    v_permlane16_swap_b32 v25, v27
    buffer_store_dwordx4 v[24:27], v15, s[16:19], s30 offen offset:2048 sc0 sc1
    v_pk_mul_f32 v[40:41], v[128:129], s[32:33] op_sel_hi:[1,0]
    v_pk_mul_f32 v[42:43], v[130:131], s[32:33] op_sel_hi:[1,0]
    v_exp_f32 v40, v40
    v_exp_f32 v41, v41
    v_exp_f32 v42, v42
    v_exp_f32 v43, v43
    v_pk_add_f32 v[40:41], v[40:41], 1.0 op_sel_hi:[1,0]
    v_pk_add_f32 v[42:43], v[42:43], 1.0 op_sel_hi:[1,0]
    v_rcp_f32 v40, v40
    v_rcp_f32 v41, v41
    v_rcp_f32 v42, v42
    v_rcp_f32 v43, v43
    v_pk_mul_f32 v[40:41], v[40:41], v[128:129]
    v_pk_mul_f32 v[42:43], v[42:43], v[130:131]
    v_cvt_pk_bf16_f32 v32, v40, v41
    v_cvt_pk_bf16_f32 v33, v42, v43
    v_pk_mul_f32 v[44:45], v[132:133], s[32:33] op_sel_hi:[1,0]
    v_pk_mul_f32 v[46:47], v[134:135], s[32:33] op_sel_hi:[1,0]
    v_exp_f32 v44, v44
    v_exp_f32 v45, v45
    v_exp_f32 v46, v46
    v_exp_f32 v47, v47
    v_pk_add_f32 v[44:45], v[44:45], 1.0 op_sel_hi:[1,0]
    v_pk_add_f32 v[46:47], v[46:47], 1.0 op_sel_hi:[1,0]
    v_rcp_f32 v44, v44
    v_rcp_f32 v45, v45
    v_rcp_f32 v46, v46
    v_rcp_f32 v47, v47
    v_pk_mul_f32 v[44:45], v[44:45], v[132:133]
    v_pk_mul_f32 v[46:47], v[46:47], v[134:135]
    v_cvt_pk_bf16_f32 v34, v44, v45
    v_cvt_pk_bf16_f32 v35, v46, v47
    s_nop 1
    v_permlane16_swap_b32 v32, v34
    v_permlane16_swap_b32 v33, v35
    buffer_store_dwordx4 v[32:35], v14, s[16:19], s30 offen offset:3584 sc0 sc1
    ds_write_b128 v11, v[32:35] offset:17920
    s_add_u32 s30, s27, 114688
    v_pk_mul_f32 v[40:41], v[148:149], s[32:33] op_sel_hi:[1,0]
    v_pk_mul_f32 v[42:43], v[150:151], s[32:33] op_sel_hi:[1,0]
    v_exp_f32 v40, v40
    v_exp_f32 v41, v41
    v_exp_f32 v42, v42
    v_exp_f32 v43, v43
    v_pk_add_f32 v[40:41], v[40:41], 1.0 op_sel_hi:[1,0]
    v_pk_add_f32 v[42:43], v[42:43], 1.0 op_sel_hi:[1,0]
    v_rcp_f32 v40, v40
    v_rcp_f32 v41, v41
    v_rcp_f32 v42, v42
    v_rcp_f32 v43, v43
    v_pk_mul_f32 v[40:41], v[40:41], v[148:149]
    v_pk_mul_f32 v[42:43], v[42:43], v[150:151]
    v_cvt_pk_bf16_f32 v28, v40, v41
    v_cvt_pk_bf16_f32 v29, v42, v43
    v_pk_mul_f32 v[44:45], v[164:165], s[32:33] op_sel_hi:[1,0]
    v_pk_mul_f32 v[46:47], v[166:167], s[32:33] op_sel_hi:[1,0]
    v_exp_f32 v44, v44
    v_exp_f32 v45, v45
    v_exp_f32 v46, v46
    v_exp_f32 v47, v47
    v_pk_add_f32 v[44:45], v[44:45], 1.0 op_sel_hi:[1,0]
    v_pk_add_f32 v[46:47], v[46:47], 1.0 op_sel_hi:[1,0]
    v_rcp_f32 v44, v44
    v_rcp_f32 v45, v45
    v_rcp_f32 v46, v46
    v_rcp_f32 v47, v47
    v_pk_mul_f32 v[44:45], v[44:45], v[164:165]
    v_pk_mul_f32 v[46:47], v[46:47], v[166:167]
    v_cvt_pk_bf16_f32 v30, v44, v45
    v_cvt_pk_bf16_f32 v31, v46, v47
    s_nop 1
    v_permlane16_swap_b32 v28, v30
    v_permlane16_swap_b32 v29, v31
    buffer_store_dwordx4 v[28:31], v15, s[16:19], s30 offen offset:0 sc0 sc1
    ds_write_b128 v10, v[28:31] offset:34816
    v_pk_mul_f32 v[40:41], v[180:181], s[32:33] op_sel_hi:[1,0]
    v_pk_mul_f32 v[42:43], v[182:183], s[32:33] op_sel_hi:[1,0]
    v_exp_f32 v40, v40
    v_exp_f32 v41, v41
    v_exp_f32 v42, v42
    v_exp_f32 v43, v43
    v_pk_add_f32 v[40:41], v[40:41], 1.0 op_sel_hi:[1,0]
    v_pk_add_f32 v[42:43], v[42:43], 1.0 op_sel_hi:[1,0]
    v_rcp_f32 v40, v40
    v_rcp_f32 v41, v41
    v_rcp_f32 v42, v42
    v_rcp_f32 v43, v43
    v_pk_mul_f32 v[40:41], v[40:41], v[180:181]
    v_pk_mul_f32 v[42:43], v[42:43], v[182:183]
    v_cvt_pk_bf16_f32 v16, v40, v41
    v_cvt_pk_bf16_f32 v17, v42, v43
    v_pk_mul_f32 v[44:45], v[196:197], s[32:33] op_sel_hi:[1,0]
    v_pk_mul_f32 v[46:47], v[198:199], s[32:33] op_sel_hi:[1,0]
    v_exp_f32 v44, v44
    v_exp_f32 v45, v45
    v_exp_f32 v46, v46
    v_exp_f32 v47, v47
    v_pk_add_f32 v[44:45], v[44:45], 1.0 op_sel_hi:[1,0]
    v_pk_add_f32 v[46:47], v[46:47], 1.0 op_sel_hi:[1,0]
    v_rcp_f32 v44, v44
    v_rcp_f32 v45, v45
    v_rcp_f32 v46, v46
    v_rcp_f32 v47, v47
    v_pk_mul_f32 v[44:45], v[44:45], v[196:197]
    v_pk_mul_f32 v[46:47], v[46:47], v[198:199]
    v_cvt_pk_bf16_f32 v18, v44, v45
    v_cvt_pk_bf16_f32 v19, v46, v47
    s_nop 1
    v_permlane16_swap_b32 v16, v18
    v_permlane16_swap_b32 v17, v19
    buffer_store_dwordx4 v[16:19], v15, s[16:19], s30 offen offset:1024 sc0 sc1
    ds_write_b128 v10, v[16:19] offset:35840
    v_pk_mul_f32 v[40:41], v[212:213], s[32:33] op_sel_hi:[1,0]
    v_pk_mul_f32 v[42:43], v[214:215], s[32:33] op_sel_hi:[1,0]
    v_exp_f32 v40, v40
    v_exp_f32 v41, v41
    v_exp_f32 v42, v42
    v_exp_f32 v43, v43
    v_pk_add_f32 v[40:41], v[40:41], 1.0 op_sel_hi:[1,0]
    v_pk_add_f32 v[42:43], v[42:43], 1.0 op_sel_hi:[1,0]
    v_rcp_f32 v40, v40
    v_rcp_f32 v41, v41
    v_rcp_f32 v42, v42
    v_rcp_f32 v43, v43
    v_pk_mul_f32 v[40:41], v[40:41], v[212:213]
    v_pk_mul_f32 v[42:43], v[42:43], v[214:215]
    v_cvt_pk_bf16_f32 v20, v40, v41
    v_cvt_pk_bf16_f32 v21, v42, v43
    v_pk_mul_f32 v[44:45], v[228:229], s[32:33] op_sel_hi:[1,0]
    v_pk_mul_f32 v[46:47], v[230:231], s[32:33] op_sel_hi:[1,0]
    v_exp_f32 v44, v44
    v_exp_f32 v45, v45
    v_exp_f32 v46, v46
    v_exp_f32 v47, v47
    v_pk_add_f32 v[44:45], v[44:45], 1.0 op_sel_hi:[1,0]
    v_pk_add_f32 v[46:47], v[46:47], 1.0 op_sel_hi:[1,0]
    v_rcp_f32 v44, v44
    v_rcp_f32 v45, v45
    v_rcp_f32 v46, v46
    v_rcp_f32 v47, v47
    v_pk_mul_f32 v[44:45], v[44:45], v[228:229]
    v_pk_mul_f32 v[46:47], v[46:47], v[230:231]
    v_cvt_pk_bf16_f32 v22, v44, v45
    v_cvt_pk_bf16_f32 v23, v46, v47
    s_nop 1
    v_permlane16_swap_b32 v20, v22
    v_permlane16_swap_b32 v21, v23
    buffer_store_dwordx4 v[20:23], v15, s[16:19], s30 offen offset:2048 sc0 sc1
    s_add_u32 s30, s27, 229376
    v_pk_mul_f32 v[40:41], v[152:153], s[32:33] op_sel_hi:[1,0]
    v_pk_mul_f32 v[42:43], v[154:155], s[32:33] op_sel_hi:[1,0]
    v_exp_f32 v40, v40
    v_exp_f32 v41, v41
    v_exp_f32 v42, v42
    v_exp_f32 v43, v43
    v_pk_add_f32 v[40:41], v[40:41], 1.0 op_sel_hi:[1,0]
    v_pk_add_f32 v[42:43], v[42:43], 1.0 op_sel_hi:[1,0]
    v_rcp_f32 v40, v40
    v_rcp_f32 v41, v41
    v_rcp_f32 v42, v42
    v_rcp_f32 v43, v43
    v_pk_mul_f32 v[40:41], v[40:41], v[152:153]
    v_pk_mul_f32 v[42:43], v[42:43], v[154:155]
    v_cvt_pk_bf16_f32 v24, v40, v41
    v_cvt_pk_bf16_f32 v25, v42, v43
    v_pk_mul_f32 v[44:45], v[168:169], s[32:33] op_sel_hi:[1,0]
    v_pk_mul_f32 v[46:47], v[170:171], s[32:33] op_sel_hi:[1,0]
    v_exp_f32 v44, v44
    v_exp_f32 v45, v45
    v_exp_f32 v46, v46
    v_exp_f32 v47, v47
    v_pk_add_f32 v[44:45], v[44:45], 1.0 op_sel_hi:[1,0]
    v_pk_add_f32 v[46:47], v[46:47], 1.0 op_sel_hi:[1,0]
    v_rcp_f32 v44, v44
    v_rcp_f32 v45, v45
    v_rcp_f32 v46, v46
    v_rcp_f32 v47, v47
    v_pk_mul_f32 v[44:45], v[44:45], v[168:169]
    v_pk_mul_f32 v[46:47], v[46:47], v[170:171]
    v_cvt_pk_bf16_f32 v26, v44, v45
    v_cvt_pk_bf16_f32 v27, v46, v47
    s_nop 1
    v_permlane16_swap_b32 v24, v26
    v_permlane16_swap_b32 v25, v27
    buffer_store_dwordx4 v[24:27], v15, s[16:19], s30 offen offset:0 sc0 sc1
    ds_write_b128 v10, v[24:27] offset:36864
    v_pk_mul_f32 v[40:41], v[184:185], s[32:33] op_sel_hi:[1,0]
    v_pk_mul_f32 v[42:43], v[186:187], s[32:33] op_sel_hi:[1,0]
    v_exp_f32 v40, v40
    v_exp_f32 v41, v41
    v_exp_f32 v42, v42
    v_exp_f32 v43, v43
    v_pk_add_f32 v[40:41], v[40:41], 1.0 op_sel_hi:[1,0]
    v_pk_add_f32 v[42:43], v[42:43], 1.0 op_sel_hi:[1,0]
    v_rcp_f32 v40, v40
    v_rcp_f32 v41, v41
    v_rcp_f32 v42, v42
    v_rcp_f32 v43, v43
    v_pk_mul_f32 v[40:41], v[40:41], v[184:185]
    v_pk_mul_f32 v[42:43], v[42:43], v[186:187]
    v_cvt_pk_bf16_f32 v28, v40, v41
    v_cvt_pk_bf16_f32 v29, v42, v43
    v_pk_mul_f32 v[44:45], v[200:201], s[32:33] op_sel_hi:[1,0]
    v_pk_mul_f32 v[46:47], v[202:203], s[32:33] op_sel_hi:[1,0]
    v_exp_f32 v44, v44
    v_exp_f32 v45, v45
    v_exp_f32 v46, v46
    v_exp_f32 v47, v47
    v_pk_add_f32 v[44:45], v[44:45], 1.0 op_sel_hi:[1,0]
    v_pk_add_f32 v[46:47], v[46:47], 1.0 op_sel_hi:[1,0]
    v_rcp_f32 v44, v44
    v_rcp_f32 v45, v45
    v_rcp_f32 v46, v46
    v_rcp_f32 v47, v47
    v_pk_mul_f32 v[44:45], v[44:45], v[200:201]
    v_pk_mul_f32 v[46:47], v[46:47], v[202:203]
    v_cvt_pk_bf16_f32 v30, v44, v45
    v_cvt_pk_bf16_f32 v31, v46, v47
    s_nop 1
    v_permlane16_swap_b32 v28, v30
    v_permlane16_swap_b32 v29, v31
    buffer_store_dwordx4 v[28:31], v15, s[16:19], s30 offen offset:1024 sc0 sc1
    ds_write_b128 v10, v[28:31] offset:37888
    v_pk_mul_f32 v[40:41], v[216:217], s[32:33] op_sel_hi:[1,0]
    v_pk_mul_f32 v[42:43], v[218:219], s[32:33] op_sel_hi:[1,0]
    v_exp_f32 v40, v40
    v_exp_f32 v41, v41
    v_exp_f32 v42, v42
    v_exp_f32 v43, v43
    v_pk_add_f32 v[40:41], v[40:41], 1.0 op_sel_hi:[1,0]
    v_pk_add_f32 v[42:43], v[42:43], 1.0 op_sel_hi:[1,0]
    v_rcp_f32 v40, v40
    v_rcp_f32 v41, v41
    v_rcp_f32 v42, v42
    v_rcp_f32 v43, v43
    v_pk_mul_f32 v[40:41], v[40:41], v[216:217]
    v_pk_mul_f32 v[42:43], v[42:43], v[218:219]
    v_cvt_pk_bf16_f32 v16, v40, v41
    v_cvt_pk_bf16_f32 v17, v42, v43
    v_pk_mul_f32 v[44:45], v[232:233], s[32:33] op_sel_hi:[1,0]
    v_pk_mul_f32 v[46:47], v[234:235], s[32:33] op_sel_hi:[1,0]
    v_exp_f32 v44, v44
    v_exp_f32 v45, v45
    v_exp_f32 v46, v46
    v_exp_f32 v47, v47
    v_pk_add_f32 v[44:45], v[44:45], 1.0 op_sel_hi:[1,0]
    v_pk_add_f32 v[46:47], v[46:47], 1.0 op_sel_hi:[1,0]
    v_rcp_f32 v44, v44
    v_rcp_f32 v45, v45
    v_rcp_f32 v46, v46
    v_rcp_f32 v47, v47
    v_pk_mul_f32 v[44:45], v[44:45], v[232:233]
    v_pk_mul_f32 v[46:47], v[46:47], v[234:235]
    v_cvt_pk_bf16_f32 v18, v44, v45
    v_cvt_pk_bf16_f32 v19, v46, v47
    s_nop 1
    v_permlane16_swap_b32 v16, v18
    v_permlane16_swap_b32 v17, v19
    buffer_store_dwordx4 v[16:19], v15, s[16:19], s30 offen offset:2048 sc0 sc1
    v_pk_mul_f32 v[40:41], v[136:137], s[32:33] op_sel_hi:[1,0]
    v_pk_mul_f32 v[42:43], v[138:139], s[32:33] op_sel_hi:[1,0]
    v_exp_f32 v40, v40
    v_exp_f32 v41, v41
    v_exp_f32 v42, v42
    v_exp_f32 v43, v43
    v_pk_add_f32 v[40:41], v[40:41], 1.0 op_sel_hi:[1,0]
    v_pk_add_f32 v[42:43], v[42:43], 1.0 op_sel_hi:[1,0]
    v_rcp_f32 v40, v40
    v_rcp_f32 v41, v41
    v_rcp_f32 v42, v42
    v_rcp_f32 v43, v43
    v_pk_mul_f32 v[40:41], v[40:41], v[136:137]
    v_pk_mul_f32 v[42:43], v[42:43], v[138:139]
    v_cvt_pk_bf16_f32 v36, v40, v41
    v_cvt_pk_bf16_f32 v37, v42, v43
    v_pk_mul_f32 v[44:45], v[140:141], s[32:33] op_sel_hi:[1,0]
    v_pk_mul_f32 v[46:47], v[142:143], s[32:33] op_sel_hi:[1,0]
    v_exp_f32 v44, v44
    v_exp_f32 v45, v45
    v_exp_f32 v46, v46
    v_exp_f32 v47, v47
    v_pk_add_f32 v[44:45], v[44:45], 1.0 op_sel_hi:[1,0]
    v_pk_add_f32 v[46:47], v[46:47], 1.0 op_sel_hi:[1,0]
    v_rcp_f32 v44, v44
    v_rcp_f32 v45, v45
    v_rcp_f32 v46, v46
    v_rcp_f32 v47, v47
    v_pk_mul_f32 v[44:45], v[44:45], v[140:141]
    v_pk_mul_f32 v[46:47], v[46:47], v[142:143]
    v_cvt_pk_bf16_f32 v38, v44, v45
    v_cvt_pk_bf16_f32 v39, v46, v47
    s_nop 1
    v_permlane16_swap_b32 v36, v38
    v_permlane16_swap_b32 v37, v39
    buffer_store_dwordx4 v[36:39], v14, s[16:19], s30 offen offset:3584 sc0 sc1
    ds_write_b128 v11, v[36:39] offset:22016
    s_add_u32 s30, s27, 344064
    v_pk_mul_f32 v[40:41], v[156:157], s[32:33] op_sel_hi:[1,0]
    v_pk_mul_f32 v[42:43], v[158:159], s[32:33] op_sel_hi:[1,0]
    v_exp_f32 v40, v40
    v_exp_f32 v41, v41
    v_exp_f32 v42, v42
    v_exp_f32 v43, v43
    v_pk_add_f32 v[40:41], v[40:41], 1.0 op_sel_hi:[1,0]
    v_pk_add_f32 v[42:43], v[42:43], 1.0 op_sel_hi:[1,0]
    v_rcp_f32 v40, v40
    v_rcp_f32 v41, v41
    v_rcp_f32 v42, v42
    v_rcp_f32 v43, v43
    v_pk_mul_f32 v[40:41], v[40:41], v[156:157]
    v_pk_mul_f32 v[42:43], v[42:43], v[158:159]
    v_cvt_pk_bf16_f32 v20, v40, v41
    v_cvt_pk_bf16_f32 v21, v42, v43
    v_pk_mul_f32 v[44:45], v[172:173], s[32:33] op_sel_hi:[1,0]
    v_pk_mul_f32 v[46:47], v[174:175], s[32:33] op_sel_hi:[1,0]
    v_exp_f32 v44, v44
    v_exp_f32 v45, v45
    v_exp_f32 v46, v46
    v_exp_f32 v47, v47
    v_pk_add_f32 v[44:45], v[44:45], 1.0 op_sel_hi:[1,0]
    v_pk_add_f32 v[46:47], v[46:47], 1.0 op_sel_hi:[1,0]
    v_rcp_f32 v44, v44
    v_rcp_f32 v45, v45
    v_rcp_f32 v46, v46
    v_rcp_f32 v47, v47
    v_pk_mul_f32 v[44:45], v[44:45], v[172:173]
    v_pk_mul_f32 v[46:47], v[46:47], v[174:175]
    v_cvt_pk_bf16_f32 v22, v44, v45
    v_cvt_pk_bf16_f32 v23, v46, v47
    s_nop 1
    v_permlane16_swap_b32 v20, v22
    v_permlane16_swap_b32 v21, v23
    buffer_store_dwordx4 v[20:23], v15, s[16:19], s30 offen offset:0 sc0 sc1
    ds_write_b128 v10, v[20:23] offset:38912
    v_pk_mul_f32 v[40:41], v[188:189], s[32:33] op_sel_hi:[1,0]
    v_pk_mul_f32 v[42:43], v[190:191], s[32:33] op_sel_hi:[1,0]
    v_exp_f32 v40, v40
    v_exp_f32 v41, v41
    v_exp_f32 v42, v42
    v_exp_f32 v43, v43
    v_pk_add_f32 v[40:41], v[40:41], 1.0 op_sel_hi:[1,0]
    v_pk_add_f32 v[42:43], v[42:43], 1.0 op_sel_hi:[1,0]
    v_rcp_f32 v40, v40
    v_rcp_f32 v41, v41
    v_rcp_f32 v42, v42
    v_rcp_f32 v43, v43
    v_pk_mul_f32 v[40:41], v[40:41], v[188:189]
    v_pk_mul_f32 v[42:43], v[42:43], v[190:191]
    v_cvt_pk_bf16_f32 v24, v40, v41
    v_cvt_pk_bf16_f32 v25, v42, v43
    v_pk_mul_f32 v[44:45], v[204:205], s[32:33] op_sel_hi:[1,0]
    v_pk_mul_f32 v[46:47], v[206:207], s[32:33] op_sel_hi:[1,0]
    v_exp_f32 v44, v44
    v_exp_f32 v45, v45
    v_exp_f32 v46, v46
    v_exp_f32 v47, v47
    v_pk_add_f32 v[44:45], v[44:45], 1.0 op_sel_hi:[1,0]
    v_pk_add_f32 v[46:47], v[46:47], 1.0 op_sel_hi:[1,0]
    v_rcp_f32 v44, v44
    v_rcp_f32 v45, v45
    v_rcp_f32 v46, v46
    v_rcp_f32 v47, v47
    v_pk_mul_f32 v[44:45], v[44:45], v[204:205]
    v_pk_mul_f32 v[46:47], v[46:47], v[206:207]
    v_cvt_pk_bf16_f32 v26, v44, v45
    v_cvt_pk_bf16_f32 v27, v46, v47
    s_nop 1
    v_permlane16_swap_b32 v24, v26
    v_permlane16_swap_b32 v25, v27
    buffer_store_dwordx4 v[24:27], v15, s[16:19], s30 offen offset:1024 sc0 sc1
    ds_write_b128 v10, v[24:27] offset:39936
    v_pk_mul_f32 v[40:41], v[220:221], s[32:33] op_sel_hi:[1,0]
    v_pk_mul_f32 v[42:43], v[222:223], s[32:33] op_sel_hi:[1,0]
    v_exp_f32 v40, v40
    v_exp_f32 v41, v41
    v_exp_f32 v42, v42
    v_exp_f32 v43, v43
    v_pk_add_f32 v[40:41], v[40:41], 1.0 op_sel_hi:[1,0]
    v_pk_add_f32 v[42:43], v[42:43], 1.0 op_sel_hi:[1,0]
    v_rcp_f32 v40, v40
    v_rcp_f32 v41, v41
    v_rcp_f32 v42, v42
    v_rcp_f32 v43, v43
    v_pk_mul_f32 v[40:41], v[40:41], v[220:221]
    v_pk_mul_f32 v[42:43], v[42:43], v[222:223]
    v_cvt_pk_bf16_f32 v28, v40, v41
    v_cvt_pk_bf16_f32 v29, v42, v43
    v_pk_mul_f32 v[44:45], v[236:237], s[32:33] op_sel_hi:[1,0]
    v_pk_mul_f32 v[46:47], v[238:239], s[32:33] op_sel_hi:[1,0]
    v_exp_f32 v44, v44
    v_exp_f32 v45, v45
    v_exp_f32 v46, v46
    v_exp_f32 v47, v47
    v_pk_add_f32 v[44:45], v[44:45], 1.0 op_sel_hi:[1,0]
    v_pk_add_f32 v[46:47], v[46:47], 1.0 op_sel_hi:[1,0]
    v_rcp_f32 v44, v44
    v_rcp_f32 v45, v45
    v_rcp_f32 v46, v46
    v_rcp_f32 v47, v47
    v_pk_mul_f32 v[44:45], v[44:45], v[236:237]
    v_pk_mul_f32 v[46:47], v[46:47], v[238:239]
    v_cvt_pk_bf16_f32 v30, v44, v45
    v_cvt_pk_bf16_f32 v31, v46, v47
    s_nop 1
    v_permlane16_swap_b32 v28, v30
    v_permlane16_swap_b32 v29, v31
    buffer_store_dwordx4 v[28:31], v15, s[16:19], s30 offen offset:2048 sc0 sc1
f1_kernel_epi2:
    s_lshl_b32 s62, s21, 4
    s_add_u32 s62, s62, s22
    s_lshl_b32 s62, s62, 10
    s_lshr_b32 s52, s22, 3
    s_and_b32 s22, s22, 7
    v_lshl_add_u32 v81, v110, 11, v108
    s_lshl_b32 s30, s21, 1
    s_add_u32 s30, s30, s28
    s_lshl_b32 s30, s30, 17
    s_lshl_b32 s31, s22, 1
    s_add_u32 s31, s31, s29
    s_lshl_b32 s31, s31, 1
    s_add_u32 s31, s31, s52
    s_lshl_b32 s31, s31, 6
    s_add_u32 s30, s30, s31
    s_lshl_b32 s31, s31, 1
    s_add_u32 s31, s31, 20480
    v_lshrrev_b32 v14, 4, v2
    v_lshrrev_b32 v80, 2, v110
    v_lshl_add_u32 v82, v14, 3, v80
    v_and_b32 v83, 1, v14
    v_xor_b32 v83, s29, v83
    v_lshl_or_b32 v80, v83, 2, v80
    v_lshlrev_b32 v80, 5, v80
    v_and_b32 v83, 3, v2
    v_lshl_add_u32 v80, v83, 3, v80
    v_lshl_add_u32 v13, v82, 8, v80
    s_lshl_b32 s27, s52, 6
    v_xor_b32 v13, s27, v13
    s_lshl_b32 s27, s28, 13
    s_add_u32 s27, s27, 65536
    v_add_u32 v12, s27, v3
    v_mov_b32 v83, 0
    v_mov_b32 v94, s83
    v_mov_b32 v92, 161792
    s_mov_b32 s26, 49152
    s_add_u32 s26, s26, 16384
    s_and_b32 s26, s26, 0xffff
    v_add_u32 v8, s26, v13
    v_add_u32 v4, s26, v12
    v_xor_b32 v9, 32, v8
    v_xor_b32 v10, 64, v8
    v_xor_b32 v11, 96, v8
    s_add_u32 s8, s4, 0xc00000
    s_addc_u32 s9, s5, 0
    s_mov_b32 s10, 0x400000
    s_mov_b32 s11, 0x20000
    s_add_u32 s12, s4, 0x2000000
    s_addc_u32 s13, s5, 0
    s_mov_b32 s14, 0xc000
    s_mov_b32 s15, 0x20000
    s_mov_b32 s16, s78
    s_mov_b32 s17, s79
    s_mov_b32 s18, 0x400000
    s_mov_b32 s19, 0x20000
    v_lshlrev_b32 v15, 1, v108
    s_add_u32 s25, s31, 24576
    s_mov_b32 s23, 28
    s_waitcnt lgkmcnt(0)
    s_barrier
    ds_read_b64_tr_b16 v[32:33], v8 offset:0
    ds_read_b64_tr_b16 v[34:35], v8 offset:1024
    ds_read_b128 v[16:19], v4 offset:0
    ds_read_b128 v[20:23], v4 offset:2048
    ds_read_b128 v[24:27], v4 offset:4096
    ds_read_b128 v[28:31], v4 offset:6144
    ds_read_b64_tr_b16 v[36:37], v9 offset:0
    ds_read_b64_tr_b16 v[38:39], v9 offset:1024
    ds_read_b64_tr_b16 v[40:41], v10 offset:0
    ds_read_b64_tr_b16 v[42:43], v10 offset:1024
    ds_read_b64_tr_b16 v[44:45], v11 offset:0
    ds_read_b64_tr_b16 v[46:47], v11 offset:1024
    v_mov_b32 v128, 0
    v_mov_b32 v129, 0
    v_mov_b32 v130, 0
    v_mov_b32 v131, 0
    v_mov_b32 v132, 0
    v_mov_b32 v133, 0
    v_mov_b32 v134, 0
    v_mov_b32 v135, 0
    v_mov_b32 v136, 0
    v_mov_b32 v137, 0
    v_mov_b32 v138, 0
    v_mov_b32 v139, 0
    v_mov_b32 v140, 0
    v_mov_b32 v141, 0
    v_mov_b32 v142, 0
    v_mov_b32 v143, 0
    v_mov_b32 v144, 0
    v_mov_b32 v145, 0
    v_mov_b32 v146, 0
    v_mov_b32 v147, 0
    v_mov_b32 v148, 0
    v_mov_b32 v149, 0
    v_mov_b32 v150, 0
    v_mov_b32 v151, 0
    v_mov_b32 v152, 0
    v_mov_b32 v153, 0
    v_mov_b32 v154, 0
    v_mov_b32 v155, 0
    v_mov_b32 v156, 0
    v_mov_b32 v157, 0
    v_mov_b32 v158, 0
    v_mov_b32 v159, 0
    v_mov_b32 v160, 0
    v_mov_b32 v161, 0
    v_mov_b32 v162, 0
    v_mov_b32 v163, 0
    v_mov_b32 v164, 0
    v_mov_b32 v165, 0
    v_mov_b32 v166, 0
    v_mov_b32 v167, 0
    v_mov_b32 v168, 0
    v_mov_b32 v169, 0
    v_mov_b32 v170, 0
    v_mov_b32 v171, 0
    v_mov_b32 v172, 0
    v_mov_b32 v173, 0
    v_mov_b32 v174, 0
    v_mov_b32 v175, 0
    v_mov_b32 v176, 0
    v_mov_b32 v177, 0
    v_mov_b32 v178, 0
    v_mov_b32 v179, 0
    v_mov_b32 v180, 0
    v_mov_b32 v181, 0
    v_mov_b32 v182, 0
    v_mov_b32 v183, 0
    v_mov_b32 v184, 0
    v_mov_b32 v185, 0
    v_mov_b32 v186, 0
    v_mov_b32 v187, 0
    v_mov_b32 v188, 0
    v_mov_b32 v189, 0
    v_mov_b32 v190, 0
    v_mov_b32 v191, 0
    v_mov_b32 v93, 1
    s_waitcnt vmcnt(0)
    s_mov_b64 exec, 1
    ds_add_rtn_u32 v93, v92, v93 offset:24
    s_waitcnt lgkmcnt(0)
    v_cmp_eq_u32 vcc, 3, v93
    v_mov_b32 v93, s83
    s_nop 0
    s_cbranch_vccz f1_kernel_aa
    buffer_store_dword v93, off, s[56:59], s62 offset:640 sc0 sc1
f1_kernel_aa:
    s_mov_b64 exec, -1
    s_add_u32 s32, s30, 0
    buffer_load_dwordx4 v[96:99], v81, s[8:11], s32 offen sc0 sc1
    s_add_u32 s33, s30, 32768
    buffer_load_dwordx4 v[100:103], v81, s[8:11], s33 offen sc0 sc1
    s_add_u32 s34, s30, 65536
    buffer_load_dwordx4 v[104:107], v81, s[8:11], s34 offen sc0 sc1
    s_add_u32 s35, s30, 98304
    buffer_load_dwordx4 v[108:111], v81, s[8:11], s35 offen sc0 sc1
    buffer_load_dwordx4 v[112:115], v15, s[12:15], s31 offen offset:0 sc0 sc1
    buffer_load_dwordx4 v[116:119], v15, s[12:15], s31 offen offset:16 sc0 sc1
    buffer_load_dwordx4 v[120:123], v15, s[12:15], s25 offen offset:0 sc0 sc1
    buffer_load_dwordx4 v[124:127], v15, s[12:15], s25 offen offset:16 sc0 sc1
    s_add_u32 s8, s4, 0x2400000
    s_addc_u32 s9, s5, 0
    s_mov_b32 s10, 0x400000
    s_mov_b32 s11, 0x20000
.p2align 6
f1_kernel_g2c:
    s_waitcnt lgkmcnt(0)
    v_mfma_f32_16x16x32_bf16 v[128:131], v[32:35], v[16:19], v[128:131]
    ds_read_b64_tr_b16 v[64:65], v8 offset:8192
    v_mfma_f32_16x16x32_bf16 v[132:135], v[32:35], v[20:23], v[132:135]
    ds_read_b64_tr_b16 v[66:67], v8 offset:9216
    v_mfma_f32_16x16x32_bf16 v[136:139], v[32:35], v[24:27], v[136:139]
    ds_read_b128 v[48:51], v4 offset:1024
    v_mfma_f32_16x16x32_bf16 v[140:143], v[32:35], v[28:31], v[140:143]
    ds_read_b128 v[52:55], v4 offset:3072
    v_mfma_f32_16x16x32_bf16 v[144:147], v[36:39], v[16:19], v[144:147]
    ds_read_b128 v[56:59], v4 offset:5120
    v_mfma_f32_16x16x32_bf16 v[148:151], v[36:39], v[20:23], v[148:151]
    ds_read_b128 v[60:63], v4 offset:7168
    v_mfma_f32_16x16x32_bf16 v[152:155], v[36:39], v[24:27], v[152:155]
    ds_read_b64_tr_b16 v[68:69], v9 offset:8192
    v_mfma_f32_16x16x32_bf16 v[156:159], v[36:39], v[28:31], v[156:159]
    ds_read_b64_tr_b16 v[70:71], v9 offset:9216
    v_mfma_f32_16x16x32_bf16 v[160:163], v[40:43], v[16:19], v[160:163]
    ds_read_b64_tr_b16 v[72:73], v10 offset:8192
    v_mfma_f32_16x16x32_bf16 v[164:167], v[40:43], v[20:23], v[164:167]
    ds_read_b64_tr_b16 v[74:75], v10 offset:9216
    v_mfma_f32_16x16x32_bf16 v[168:171], v[40:43], v[24:27], v[168:171]
    ds_read_b64_tr_b16 v[76:77], v11 offset:8192
    v_mfma_f32_16x16x32_bf16 v[172:175], v[40:43], v[28:31], v[172:175]
    ds_read_b64_tr_b16 v[78:79], v11 offset:9216
    v_mfma_f32_16x16x32_bf16 v[176:179], v[44:47], v[16:19], v[176:179]
    s_add_u32 s26, s26, 16384
    s_and_b32 s26, s26, 0xffff
    v_mfma_f32_16x16x32_bf16 v[180:183], v[44:47], v[20:23], v[180:183]
    v_add_u32 v8, s26, v13
    v_add_u32 v4, s26, v12
    v_mfma_f32_16x16x32_bf16 v[184:187], v[44:47], v[24:27], v[184:187]
    v_xor_b32 v9, 32, v8
    v_xor_b32 v10, 64, v8
    v_mfma_f32_16x16x32_bf16 v[188:191], v[44:47], v[28:31], v[188:191]
    v_xor_b32 v11, 96, v8
    s_waitcnt lgkmcnt(0)
    s_barrier
    v_mfma_f32_16x16x32_bf16 v[128:131], v[64:67], v[48:51], v[128:131]
    ds_read_b64_tr_b16 v[32:33], v8 offset:0
    v_mfma_f32_16x16x32_bf16 v[132:135], v[64:67], v[52:55], v[132:135]
    ds_read_b64_tr_b16 v[34:35], v8 offset:1024
    v_mfma_f32_16x16x32_bf16 v[136:139], v[64:67], v[56:59], v[136:139]
    ds_read_b128 v[16:19], v4 offset:0
    v_mfma_f32_16x16x32_bf16 v[140:143], v[64:67], v[60:63], v[140:143]
    ds_read_b128 v[20:23], v4 offset:2048
    v_mfma_f32_16x16x32_bf16 v[144:147], v[68:71], v[48:51], v[144:147]
    ds_read_b128 v[24:27], v4 offset:4096
    v_mfma_f32_16x16x32_bf16 v[148:151], v[68:71], v[52:55], v[148:151]
    ds_read_b128 v[28:31], v4 offset:6144
    v_mfma_f32_16x16x32_bf16 v[152:155], v[68:71], v[56:59], v[152:155]
    ds_read_b64_tr_b16 v[36:37], v9 offset:0
    v_mfma_f32_16x16x32_bf16 v[156:159], v[68:71], v[60:63], v[156:159]
    ds_read_b64_tr_b16 v[38:39], v9 offset:1024
    v_mfma_f32_16x16x32_bf16 v[160:163], v[72:75], v[48:51], v[160:163]
    ds_read_b64_tr_b16 v[40:41], v10 offset:0
    v_mfma_f32_16x16x32_bf16 v[164:167], v[72:75], v[52:55], v[164:167]
    ds_read_b64_tr_b16 v[42:43], v10 offset:1024
    v_mfma_f32_16x16x32_bf16 v[168:171], v[72:75], v[56:59], v[168:171]
    ds_read_b64_tr_b16 v[44:45], v11 offset:0
    v_mfma_f32_16x16x32_bf16 v[172:175], v[72:75], v[60:63], v[172:175]
    ds_read_b64_tr_b16 v[46:47], v11 offset:1024
    v_mfma_f32_16x16x32_bf16 v[176:179], v[76:79], v[48:51], v[176:179]
    s_sub_u32 s23, s23, 1
    s_cmp_lg_u32 s23, 0
    v_mfma_f32_16x16x32_bf16 v[180:183], v[76:79], v[52:55], v[180:183]
    v_mfma_f32_16x16x32_bf16 v[184:187], v[76:79], v[56:59], v[184:187]
    v_mfma_f32_16x16x32_bf16 v[188:191], v[76:79], v[60:63], v[188:191]
    s_cbranch_scc1 f1_kernel_g2c
    s_lshl_b32 s27, s2, 2
    s_add_u32 s27, s27, s20
    s_xor_b32 s36, s27, 16
    s_lshl_b32 s53, s27, 12
    s_lshl_b32 s54, s36, 12
    s_lshl_b32 s63, s2, 10
    s_lshl_b32 s27, s20, 7
    s_add_u32 s63, s63, s27
    s_xor_b32 s27, s63, 4096
    v_mov_b32 v82, s27
    s_mov_b32 s27, 0xffff0000
    s_waitcnt vmcnt(0) lgkmcnt(0)
    v_cvt_pk_bf16_f32 v160, v160, v161
    v_cvt_pk_bf16_f32 v161, v162, v163
    v_cvt_pk_bf16_f32 v162, v176, v177
    v_cvt_pk_bf16_f32 v163, v178, v179
    s_nop 1
    v_permlane16_swap_b32 v160, v162
    v_permlane16_swap_b32 v161, v163
    buffer_store_dwordx4 v[160:163], v3, s[8:11], s53 offen offset:0 sc0 sc1
    v_cvt_pk_bf16_f32 v164, v164, v165
    v_cvt_pk_bf16_f32 v165, v166, v167
    v_cvt_pk_bf16_f32 v166, v180, v181
    v_cvt_pk_bf16_f32 v167, v182, v183
    s_nop 1
    v_permlane16_swap_b32 v164, v166
    v_permlane16_swap_b32 v165, v167
    buffer_store_dwordx4 v[164:167], v3, s[8:11], s53 offen offset:1024 sc0 sc1
    v_cvt_pk_bf16_f32 v168, v168, v169
    v_cvt_pk_bf16_f32 v169, v170, v171
    v_cvt_pk_bf16_f32 v170, v184, v185
    v_cvt_pk_bf16_f32 v171, v186, v187
    s_nop 1
    v_permlane16_swap_b32 v168, v170
    v_permlane16_swap_b32 v169, v171
    buffer_store_dwordx4 v[168:171], v3, s[8:11], s53 offen offset:2048 sc0 sc1
    v_cvt_pk_bf16_f32 v172, v172, v173
    v_cvt_pk_bf16_f32 v173, v174, v175
    v_cvt_pk_bf16_f32 v174, v188, v189
    v_cvt_pk_bf16_f32 v175, v190, v191
    s_nop 1
    v_permlane16_swap_b32 v172, v174
    v_permlane16_swap_b32 v173, v175
    buffer_store_dwordx4 v[172:175], v3, s[8:11], s53 offen offset:3072 sc0 sc1
    v_pk_add_f32 v[84:85], v[112:113], v[120:121]
    v_cvt_pk_bf16_f32 v92, v84, v85
    v_lshlrev_b32 v84, 16, v92
    v_and_b32 v85, s27, v92
    v_pk_add_f32 v[86:87], v[114:115], v[122:123]
    v_cvt_pk_bf16_f32 v92, v86, v87
    v_lshlrev_b32 v86, 16, v92
    v_and_b32 v87, s27, v92
    v_pk_add_f32 v[88:89], v[116:117], v[124:125]
    v_cvt_pk_bf16_f32 v92, v88, v89
    v_lshlrev_b32 v88, 16, v92
    v_and_b32 v89, s27, v92
    v_pk_add_f32 v[90:91], v[118:119], v[126:127]
    v_cvt_pk_bf16_f32 v92, v90, v91
    v_lshlrev_b32 v90, 16, v92
    v_and_b32 v91, s27, v92
    v_permlane16_swap_b32 v128, v144
    v_permlane16_swap_b32 v129, v145
    v_permlane16_swap_b32 v130, v146
    v_permlane16_swap_b32 v131, v147
    v_lshlrev_b32 v32, 16, v96
    v_and_b32 v33, s27, v96
    v_pk_fma_f32 v[128:129], v[128:129], v[84:85], v[32:33]
    v_lshlrev_b32 v34, 16, v97
    v_and_b32 v35, s27, v97
    v_pk_fma_f32 v[130:131], v[130:131], v[86:87], v[34:35]
    v_lshlrev_b32 v32, 16, v98
    v_and_b32 v33, s27, v98
    v_pk_fma_f32 v[144:145], v[144:145], v[88:89], v[32:33]
    v_lshlrev_b32 v34, 16, v99
    v_and_b32 v35, s27, v99
    v_pk_fma_f32 v[146:147], v[146:147], v[90:91], v[34:35]
    v_permlane16_swap_b32 v132, v148
    v_permlane16_swap_b32 v133, v149
    v_permlane16_swap_b32 v134, v150
    v_permlane16_swap_b32 v135, v151
    v_lshlrev_b32 v32, 16, v100
    v_and_b32 v33, s27, v100
    v_pk_fma_f32 v[132:133], v[132:133], v[84:85], v[32:33]
    v_lshlrev_b32 v34, 16, v101
    v_and_b32 v35, s27, v101
    v_pk_fma_f32 v[134:135], v[134:135], v[86:87], v[34:35]
    v_lshlrev_b32 v32, 16, v102
    v_and_b32 v33, s27, v102
    v_pk_fma_f32 v[148:149], v[148:149], v[88:89], v[32:33]
    v_lshlrev_b32 v34, 16, v103
    v_and_b32 v35, s27, v103
    v_pk_fma_f32 v[150:151], v[150:151], v[90:91], v[34:35]
    s_waitcnt vmcnt(0)
    s_mov_b64 exec, 1
    buffer_store_dword v94, off, s[56:59], s63 sc0 sc1
    s_mov_b64 exec, -1
    v_permlane16_swap_b32 v136, v152
    v_permlane16_swap_b32 v137, v153
    v_permlane16_swap_b32 v138, v154
    v_permlane16_swap_b32 v139, v155
    v_lshlrev_b32 v32, 16, v104
    v_and_b32 v33, s27, v104
    v_pk_fma_f32 v[136:137], v[136:137], v[84:85], v[32:33]
    v_lshlrev_b32 v34, 16, v105
    v_and_b32 v35, s27, v105
    v_pk_fma_f32 v[138:139], v[138:139], v[86:87], v[34:35]
    v_lshlrev_b32 v32, 16, v106
    v_and_b32 v33, s27, v106
    v_pk_fma_f32 v[152:153], v[152:153], v[88:89], v[32:33]
    v_lshlrev_b32 v34, 16, v107
    v_and_b32 v35, s27, v107
    v_pk_fma_f32 v[154:155], v[154:155], v[90:91], v[34:35]
    v_permlane16_swap_b32 v140, v156
    v_permlane16_swap_b32 v141, v157
    v_permlane16_swap_b32 v142, v158
    v_permlane16_swap_b32 v143, v159
    v_lshlrev_b32 v32, 16, v108
    v_and_b32 v33, s27, v108
    v_pk_fma_f32 v[140:141], v[140:141], v[84:85], v[32:33]
    v_lshlrev_b32 v34, 16, v109
    v_and_b32 v35, s27, v109
    v_pk_fma_f32 v[142:143], v[142:143], v[86:87], v[34:35]
    v_lshlrev_b32 v32, 16, v110
    v_and_b32 v33, s27, v110
    v_pk_fma_f32 v[156:157], v[156:157], v[88:89], v[32:33]
    v_lshlrev_b32 v34, 16, v111
    v_and_b32 v35, s27, v111
    v_pk_fma_f32 v[158:159], v[158:159], v[90:91], v[34:35]
    s_mov_b32 s60, 0x40000
    s_branch f1_kernel_px_in
f1_kernel_px:
    s_sleep 1
f1_kernel_px_in:
    buffer_load_dword v95, v82, s[56:59], 0 offen sc0 sc1
    s_sub_u32 s60, s60, 1
    s_cmp_eq_u32 s60, 0
    s_cbranch_scc1 f1_kernel_px_out
    s_waitcnt vmcnt(0)
    v_cmp_ne_u32 vcc, s83, v95
    s_nop 1
    s_cbranch_vccnz f1_kernel_px
f1_kernel_px_out:
    buffer_load_dwordx4 v[16:19], v3, s[8:11], s54 offen offset:0 sc0 sc1
    buffer_load_dwordx4 v[20:23], v3, s[8:11], s54 offen offset:1024 sc0 sc1
    buffer_load_dwordx4 v[24:27], v3, s[8:11], s54 offen offset:2048 sc0 sc1
    buffer_load_dwordx4 v[28:31], v3, s[8:11], s54 offen offset:3072 sc0 sc1
    s_waitcnt vmcnt(3)
    v_lshlrev_b32 v32, 16, v16
    v_and_b32 v33, s27, v16
    v_pk_fma_f32 v[32:33], v[32:33], v[84:85], v[128:129]
    v_cvt_pk_bf16_f32 v96, v32, v33
    v_lshlrev_b32 v34, 16, v17
    v_and_b32 v35, s27, v17
    v_pk_fma_f32 v[34:35], v[34:35], v[86:87], v[130:131]
    v_cvt_pk_bf16_f32 v97, v34, v35
    v_lshlrev_b32 v32, 16, v18
    v_and_b32 v33, s27, v18
    v_pk_fma_f32 v[32:33], v[32:33], v[88:89], v[144:145]
    v_cvt_pk_bf16_f32 v98, v32, v33
    v_lshlrev_b32 v34, 16, v19
    v_and_b32 v35, s27, v19
    v_pk_fma_f32 v[34:35], v[34:35], v[90:91], v[146:147]
    v_cvt_pk_bf16_f32 v99, v34, v35
    buffer_store_dwordx4 v[96:99], v81, s[16:19], s32 offen
    s_waitcnt vmcnt(3)
    v_lshlrev_b32 v32, 16, v20
    v_and_b32 v33, s27, v20
    v_pk_fma_f32 v[32:33], v[32:33], v[84:85], v[132:133]
    v_cvt_pk_bf16_f32 v100, v32, v33
    v_lshlrev_b32 v34, 16, v21
    v_and_b32 v35, s27, v21
    v_pk_fma_f32 v[34:35], v[34:35], v[86:87], v[134:135]
    v_cvt_pk_bf16_f32 v101, v34, v35
    v_lshlrev_b32 v32, 16, v22
    v_and_b32 v33, s27, v22
    v_pk_fma_f32 v[32:33], v[32:33], v[88:89], v[148:149]
    v_cvt_pk_bf16_f32 v102, v32, v33
    v_lshlrev_b32 v34, 16, v23
    v_and_b32 v35, s27, v23
    v_pk_fma_f32 v[34:35], v[34:35], v[90:91], v[150:151]
    v_cvt_pk_bf16_f32 v103, v34, v35
    buffer_store_dwordx4 v[100:103], v81, s[16:19], s33 offen
    s_waitcnt vmcnt(3)
    v_lshlrev_b32 v32, 16, v24
    v_and_b32 v33, s27, v24
    v_pk_fma_f32 v[32:33], v[32:33], v[84:85], v[136:137]
    v_cvt_pk_bf16_f32 v104, v32, v33
    v_lshlrev_b32 v34, 16, v25
    v_and_b32 v35, s27, v25
    v_pk_fma_f32 v[34:35], v[34:35], v[86:87], v[138:139]
    v_cvt_pk_bf16_f32 v105, v34, v35
    v_lshlrev_b32 v32, 16, v26
    v_and_b32 v33, s27, v26
    v_pk_fma_f32 v[32:33], v[32:33], v[88:89], v[152:153]
    v_cvt_pk_bf16_f32 v106, v32, v33
    v_lshlrev_b32 v34, 16, v27
    v_and_b32 v35, s27, v27
    v_pk_fma_f32 v[34:35], v[34:35], v[90:91], v[154:155]
    v_cvt_pk_bf16_f32 v107, v34, v35
    buffer_store_dwordx4 v[104:107], v81, s[16:19], s34 offen
    s_waitcnt vmcnt(3)
    v_lshlrev_b32 v32, 16, v28
    v_and_b32 v33, s27, v28
    v_pk_fma_f32 v[32:33], v[32:33], v[84:85], v[140:141]
    v_cvt_pk_bf16_f32 v108, v32, v33
    v_lshlrev_b32 v34, 16, v29
    v_and_b32 v35, s27, v29
    v_pk_fma_f32 v[34:35], v[34:35], v[86:87], v[142:143]
    v_cvt_pk_bf16_f32 v109, v34, v35
    v_lshlrev_b32 v32, 16, v30
    v_and_b32 v33, s27, v30
    v_pk_fma_f32 v[32:33], v[32:33], v[88:89], v[156:157]
    v_cvt_pk_bf16_f32 v110, v32, v33
    v_lshlrev_b32 v34, 16, v31
    v_and_b32 v35, s27, v31
    v_pk_fma_f32 v[34:35], v[34:35], v[90:91], v[158:159]
    v_cvt_pk_bf16_f32 v111, v34, v35
    buffer_store_dwordx4 v[108:111], v81, s[16:19], s35 offen
f1_kernel_fin:
    s_endpgm
f1_kernel_L:
    buffer_load_dwordx4 v[208:211], v205, s[28:31], s37 offen offset:0
    buffer_load_dwordx4 v[212:215], v205, s[28:31], s37 offen offset:16
    buffer_load_dwordx4 v[112:115], v204, s[12:15], s80 offen nt
    s_add_u32 s80, s80, 12288
    buffer_load_dwordx4 v[116:119], v204, s[12:15], s80 offen nt
    s_add_u32 s80, s80, 12288
    v_mov_b32 v15, 1
    s_waitcnt vmcnt(4)
    s_mov_b64 exec, 1
    ds_add_rtn_u32 v15, v14, v15 offset:16
    s_waitcnt lgkmcnt(0)
    v_cmp_eq_u32 vcc, 7, v15
    v_mov_b32 v15, s83
    s_nop 0
    s_cbranch_vccz f1_kernel_ak2
    buffer_store_dword v15, off, s[56:59], s39
    buffer_store_dword v15, off, s[56:59], s23 offset:768 sc0 sc1
f1_kernel_ak2:
    s_mov_b64 exec, -1
    s_cmp_ge_u32 s2, 192
    s_cbranch_scc1 f1_kernel_Lidle
    s_mov_b32 s39, 0xbfb8aa3b
    s_waitcnt vmcnt(2)
    v_lshlrev_b32 v32, 16, v208
    v_and_b32 v34, s27, v208
    v_lshlrev_b32 v36, 16, v209
    v_and_b32 v38, s27, v209
    v_lshlrev_b32 v40, 16, v210
    v_and_b32 v42, s27, v210
    v_lshlrev_b32 v44, 16, v211
    v_and_b32 v46, s27, v211
    v_lshlrev_b32 v48, 16, v212
    v_and_b32 v50, s27, v212
    v_lshlrev_b32 v52, 16, v213
    v_and_b32 v54, s27, v213
    v_lshlrev_b32 v56, 16, v214
    v_and_b32 v58, s27, v214
    v_lshlrev_b32 v60, 16, v215
    v_and_b32 v62, s27, v215
    v_mul_f32 v8, s39, v32
    v_mul_f32 v9, s39, v34
    v_exp_f32 v8, v8
    v_exp_f32 v9, v9
    s_nop 0
    v_add_f32 v8, 1.0, v8
    v_add_f32 v9, 1.0, v9
    v_rcp_f32 v8, v8
    v_rcp_f32 v9, v9
    s_nop 0
    v_mul_f32 v8, v8, v32
    v_mul_f32 v9, v9, v34
    v_cvt_pk_bf16_f32 v8, v8, v9
    v_lshlrev_b32 v32, 16, v8
    v_and_b32 v34, s27, v8
    v_mul_f32 v8, s39, v36
    v_mul_f32 v9, s39, v38
    v_exp_f32 v8, v8
    v_exp_f32 v9, v9
    s_nop 0
    v_add_f32 v8, 1.0, v8
    v_add_f32 v9, 1.0, v9
    v_rcp_f32 v8, v8
    v_rcp_f32 v9, v9
    s_nop 0
    v_mul_f32 v8, v8, v36
    v_mul_f32 v9, v9, v38
    v_cvt_pk_bf16_f32 v8, v8, v9
    v_lshlrev_b32 v36, 16, v8
    v_and_b32 v38, s27, v8
    v_mul_f32 v8, s39, v40
    v_mul_f32 v9, s39, v42
    v_exp_f32 v8, v8
    v_exp_f32 v9, v9
    s_nop 0
    v_add_f32 v8, 1.0, v8
    v_add_f32 v9, 1.0, v9
    v_rcp_f32 v8, v8
    v_rcp_f32 v9, v9
    s_nop 0
    v_mul_f32 v8, v8, v40
    v_mul_f32 v9, v9, v42
    v_cvt_pk_bf16_f32 v8, v8, v9
    v_lshlrev_b32 v40, 16, v8
    v_and_b32 v42, s27, v8
    v_mul_f32 v8, s39, v44
    v_mul_f32 v9, s39, v46
    v_exp_f32 v8, v8
    v_exp_f32 v9, v9
    s_nop 0
    v_add_f32 v8, 1.0, v8
    v_add_f32 v9, 1.0, v9
    v_rcp_f32 v8, v8
    v_rcp_f32 v9, v9
    s_nop 0
    v_mul_f32 v8, v8, v44
    v_mul_f32 v9, v9, v46
    v_cvt_pk_bf16_f32 v8, v8, v9
    v_lshlrev_b32 v44, 16, v8
    v_and_b32 v46, s27, v8
    v_mul_f32 v8, s39, v48
    v_mul_f32 v9, s39, v50
    v_exp_f32 v8, v8
    v_exp_f32 v9, v9
    s_nop 0
    v_add_f32 v8, 1.0, v8
    v_add_f32 v9, 1.0, v9
    v_rcp_f32 v8, v8
    v_rcp_f32 v9, v9
    s_nop 0
    v_mul_f32 v8, v8, v48
    v_mul_f32 v9, v9, v50
    v_cvt_pk_bf16_f32 v8, v8, v9
    v_lshlrev_b32 v48, 16, v8
    v_and_b32 v50, s27, v8
    v_mul_f32 v8, s39, v52
    v_mul_f32 v9, s39, v54
    v_exp_f32 v8, v8
    v_exp_f32 v9, v9
    s_nop 0
    v_add_f32 v8, 1.0, v8
    v_add_f32 v9, 1.0, v9
    v_rcp_f32 v8, v8
    v_rcp_f32 v9, v9
    s_nop 0
    v_mul_f32 v8, v8, v52
    v_mul_f32 v9, v9, v54
    v_cvt_pk_bf16_f32 v8, v8, v9
    v_lshlrev_b32 v52, 16, v8
    v_and_b32 v54, s27, v8
    v_mul_f32 v8, s39, v56
    v_mul_f32 v9, s39, v58
    v_exp_f32 v8, v8
    v_exp_f32 v9, v9
    s_nop 0
    v_add_f32 v8, 1.0, v8
    v_add_f32 v9, 1.0, v9
    v_rcp_f32 v8, v8
    v_rcp_f32 v9, v9
    s_nop 0
    v_mul_f32 v8, v8, v56
    v_mul_f32 v9, v9, v58
    v_cvt_pk_bf16_f32 v8, v8, v9
    v_lshlrev_b32 v56, 16, v8
    v_and_b32 v58, s27, v8
    v_mul_f32 v8, s39, v60
    v_mul_f32 v9, s39, v62
    v_exp_f32 v8, v8
    v_exp_f32 v9, v9
    s_nop 0
    v_add_f32 v8, 1.0, v8
    v_add_f32 v9, 1.0, v9
    v_rcp_f32 v8, v8
    v_rcp_f32 v9, v9
    s_nop 0
    v_mul_f32 v8, v8, v60
    v_mul_f32 v9, v9, v62
    v_cvt_pk_bf16_f32 v8, v8, v9
    v_lshlrev_b32 v60, 16, v8
    v_and_b32 v62, s27, v8
    v_mov_b32 v16, 0
    v_mov_b32 v17, 0
    v_mov_b32 v18, 0
    v_mov_b32 v19, 0
    v_mov_b32 v20, 0
    v_mov_b32 v21, 0
    v_mov_b32 v22, 0
    v_mov_b32 v23, 0
    s_waitcnt vmcnt(2)
    v_lshlrev_b32 v8, 16, v104
    v_and_b32 v9, s27, v104
    v_pk_fma_f32 v[16:17], v[8:9], v[32:33], v[16:17] op_sel_hi:[1,0,1]
    v_lshlrev_b32 v10, 16, v105
    v_and_b32 v11, s27, v105
    v_pk_fma_f32 v[18:19], v[10:11], v[32:33], v[18:19] op_sel_hi:[1,0,1]
    v_lshlrev_b32 v8, 16, v106
    v_and_b32 v9, s27, v106
    v_pk_fma_f32 v[20:21], v[8:9], v[32:33], v[20:21] op_sel_hi:[1,0,1]
    v_lshlrev_b32 v10, 16, v107
    v_and_b32 v11, s27, v107
    v_pk_fma_f32 v[22:23], v[10:11], v[32:33], v[22:23] op_sel_hi:[1,0,1]
    s_waitcnt vmcnt(2)
    v_lshlrev_b32 v8, 16, v108
    v_and_b32 v9, s27, v108
    v_pk_fma_f32 v[16:17], v[8:9], v[34:35], v[16:17] op_sel_hi:[1,0,1]
    v_lshlrev_b32 v10, 16, v109
    v_and_b32 v11, s27, v109
    v_pk_fma_f32 v[18:19], v[10:11], v[34:35], v[18:19] op_sel_hi:[1,0,1]
    v_lshlrev_b32 v8, 16, v110
    v_and_b32 v9, s27, v110
    v_pk_fma_f32 v[20:21], v[8:9], v[34:35], v[20:21] op_sel_hi:[1,0,1]
    v_lshlrev_b32 v10, 16, v111
    v_and_b32 v11, s27, v111
    v_pk_fma_f32 v[22:23], v[10:11], v[34:35], v[22:23] op_sel_hi:[1,0,1]
    s_waitcnt vmcnt(1)
    v_lshlrev_b32 v8, 16, v112
    v_and_b32 v9, s27, v112
    v_pk_fma_f32 v[16:17], v[8:9], v[36:37], v[16:17] op_sel_hi:[1,0,1]
    v_lshlrev_b32 v10, 16, v113
    v_and_b32 v11, s27, v113
    v_pk_fma_f32 v[18:19], v[10:11], v[36:37], v[18:19] op_sel_hi:[1,0,1]
    v_lshlrev_b32 v8, 16, v114
    v_and_b32 v9, s27, v114
    v_pk_fma_f32 v[20:21], v[8:9], v[36:37], v[20:21] op_sel_hi:[1,0,1]
    v_lshlrev_b32 v10, 16, v115
    v_and_b32 v11, s27, v115
    v_pk_fma_f32 v[22:23], v[10:11], v[36:37], v[22:23] op_sel_hi:[1,0,1]
    s_waitcnt vmcnt(0)
    v_lshlrev_b32 v8, 16, v116
    v_and_b32 v9, s27, v116
    v_pk_fma_f32 v[16:17], v[8:9], v[38:39], v[16:17] op_sel_hi:[1,0,1]
    v_lshlrev_b32 v10, 16, v117
    v_and_b32 v11, s27, v117
    v_pk_fma_f32 v[18:19], v[10:11], v[38:39], v[18:19] op_sel_hi:[1,0,1]
    v_lshlrev_b32 v8, 16, v118
    v_and_b32 v9, s27, v118
    v_pk_fma_f32 v[20:21], v[8:9], v[38:39], v[20:21] op_sel_hi:[1,0,1]
    v_lshlrev_b32 v10, 16, v119
    v_and_b32 v11, s27, v119
    v_pk_fma_f32 v[22:23], v[10:11], v[38:39], v[22:23] op_sel_hi:[1,0,1]
    v_lshrrev_b32 v166, 3, v2
    v_and_b32 v175, 7, v2
    v_xor_b32 v175, v175, v166
    v_lshlrev_b32 v175, 4, v175
    v_lshl_add_u32 v175, v166, 11, v175
    s_mul_i32 s52, s63, 448
    v_add_u32 v162, s52, v2
    s_movk_i32 s52, 2341
    s_movk_i32 s53, 7168
    v_add_u32 v163, 0, v162
    v_mul_u32_u24 v164, s52, v163
    v_lshrrev_b32 v164, 16, v164
    v_mul_u32_u24 v165, 28, v164
    v_sub_u32 v163, v163, v165
    v_bfe_u32 v165, v164, 3, 1
    v_lshlrev_b32 v165, 1, v165
    v_xor_b32 v163, v163, v165
    v_mul_u32_u24 v164, s53, v164
    v_lshl_add_u32 v168, v163, 4, v164
    v_add_u32 v163, 64, v162
    v_mul_u32_u24 v164, s52, v163
    v_lshrrev_b32 v164, 16, v164
    v_mul_u32_u24 v165, 28, v164
    v_sub_u32 v163, v163, v165
    v_bfe_u32 v165, v164, 3, 1
    v_lshlrev_b32 v165, 1, v165
    v_xor_b32 v163, v163, v165
    v_mul_u32_u24 v164, s53, v164
    v_lshl_add_u32 v169, v163, 4, v164
    v_add_u32 v163, 128, v162
    v_mul_u32_u24 v164, s52, v163
    v_lshrrev_b32 v164, 16, v164
    v_mul_u32_u24 v165, 28, v164
    v_sub_u32 v163, v163, v165
    v_bfe_u32 v165, v164, 3, 1
    v_lshlrev_b32 v165, 1, v165
    v_xor_b32 v163, v163, v165
    v_mul_u32_u24 v164, s53, v164
    v_lshl_add_u32 v170, v163, 4, v164
    v_add_u32 v163, 192, v162
    v_mul_u32_u24 v164, s52, v163
    v_lshrrev_b32 v164, 16, v164
    v_mul_u32_u24 v165, 28, v164
    v_sub_u32 v163, v163, v165
    v_bfe_u32 v165, v164, 3, 1
    v_lshlrev_b32 v165, 1, v165
    v_xor_b32 v163, v163, v165
    v_mul_u32_u24 v164, s53, v164
    v_lshl_add_u32 v171, v163, 4, v164
    v_add_u32 v163, 256, v162
    v_mul_u32_u24 v164, s52, v163
    v_lshrrev_b32 v164, 16, v164
    v_mul_u32_u24 v165, 28, v164
    v_sub_u32 v163, v163, v165
    v_bfe_u32 v165, v164, 3, 1
    v_lshlrev_b32 v165, 1, v165
    v_xor_b32 v163, v163, v165
    v_mul_u32_u24 v164, s53, v164
    v_lshl_add_u32 v172, v163, 4, v164
    v_add_u32 v163, 320, v162
    v_mul_u32_u24 v164, s52, v163
    v_lshrrev_b32 v164, 16, v164
    v_mul_u32_u24 v165, 28, v164
    v_sub_u32 v163, v163, v165
    v_bfe_u32 v165, v164, 3, 1
    v_lshlrev_b32 v165, 1, v165
    v_xor_b32 v163, v163, v165
    v_mul_u32_u24 v164, s53, v164
    v_lshl_add_u32 v173, v163, 4, v164
    v_add_u32 v163, 384, v162
    v_mul_u32_u24 v164, s52, v163
    v_lshrrev_b32 v164, 16, v164
    v_mul_u32_u24 v165, 28, v164
    v_sub_u32 v163, v163, v165
    v_bfe_u32 v165, v164, 3, 1
    v_lshlrev_b32 v165, 1, v165
    v_xor_b32 v163, v163, v165
    v_mul_u32_u24 v164, s53, v164
    v_lshl_add_u32 v174, v163, 4, v164
f1_kernel_gk:
    ds_read_b32 v15, v14 offset:8
    s_waitcnt lgkmcnt(0)
    v_cmp_ne_u32 vcc, 256, v15
    s_nop 1
    s_cbranch_vccnz f1_kernel_gk
    s_mov_b32 s8, s6
    s_mov_b32 s9, s7
    s_mov_b32 s10, 0x400000
    s_mov_b32 s11, 0x20000
    buffer_load_dwordx4 v[232:235], v3, s[8:11], s61 offen offset:0 nt
    buffer_load_dwordx4 v[236:239], v3, s[8:11], s61 offen offset:1024 nt
    buffer_load_dwordx4 v[120:123], v204, s[12:15], s80 offen nt
    s_add_u32 s80, s80, 12288
    buffer_load_dwordx4 v[124:127], v204, s[12:15], s80 offen nt
    s_add_u32 s80, s80, 12288
    buffer_load_dwordx4 v[128:131], v204, s[12:15], s80 offen nt
    s_add_u32 s80, s80, 12288
    buffer_load_dwordx4 v[132:135], v204, s[12:15], s80 offen nt
    s_add_u32 s80, s80, 12288
    buffer_load_dwordx4 v[136:139], v204, s[12:15], s80 offen nt
    s_add_u32 s80, s80, 12288
    buffer_load_dwordx4 v[140:143], v204, s[12:15], s80 offen nt
    s_add_u32 s80, s80, 12288
    buffer_load_dwordx4 v[144:147], v204, s[12:15], s80 offen nt
    s_add_u32 s80, s80, 12288
    buffer_load_dwordx4 v[148:151], v204, s[12:15], s80 offen nt
    s_add_u32 s80, s80, 12288
    buffer_load_dwordx4 v[152:155], v204, s[12:15], s80 offen nt
    s_add_u32 s80, s80, 12288
    buffer_load_dwordx4 v[156:159], v204, s[12:15], s80 offen nt
    s_add_u32 s80, s80, 12288
    buffer_load_dwordx4 v[160:163], v204, s[12:15], s80 offen nt
    s_add_u32 s80, s80, 12288
    buffer_load_dwordx4 v[164:167], v204, s[12:15], s80 offen nt
    s_add_u32 s80, s80, 12288
    s_getpc_b64 s[46:47]
f1_kernel_ct1:
    s_sub_u32 s46, s46, f1_kernel_ct1-f1_kernel
    s_subb_u32 s47, s47, 0
    s_lshr_b32 s44, s2, 3
    s_lshl_b32 s44, s44, 2
    s_add_u32 s44, s44, s63
    s_mul_i32 s44, s44, 320
    s_min_u32 s44, s44, code_end-f1_kernel-320
    s_add_u32 s46, s46, s44
    s_addc_u32 s47, s47, 0
    s_load_dword s45, s[46:47], 0
    s_load_dword s45, s[46:47], 64
    s_load_dword s45, s[46:47], 128
    s_load_dword s45, s[46:47], 192
    s_load_dword s45, s[46:47], 256
    s_waitcnt vmcnt(12)
    s_lshr_b32 s52, s20, 1
    v_lshrrev_b32 v196, 1, v2
    v_xor_b32 v196, s52, v196
    v_and_b32 v196, 3, v196
    v_lshlrev_b32 v196, 4, v196
    v_lshl_add_u32 v196, v2, 7, v196
    s_and_b32 s52, s20, 1
    s_lshl_b32 s52, s52, 3
    s_add_u32 s52, s52, 135168
    v_add_u32 v196, s52, v196
    v_add_u32 v197, 151552, v3
    v_lshlrev_b32 v176, 16, v232
    v_and_b32 v177, s27, v232
    v_lshlrev_b32 v178, 16, v233
    v_and_b32 v179, s27, v233
    v_lshlrev_b32 v180, 16, v234
    v_and_b32 v181, s27, v234
    v_lshlrev_b32 v182, 16, v235
    v_and_b32 v183, s27, v235
    v_lshlrev_b32 v184, 16, v236
    v_and_b32 v185, s27, v236
    v_lshlrev_b32 v186, 16, v237
    v_and_b32 v187, s27, v237
    v_lshlrev_b32 v188, 16, v238
    v_and_b32 v189, s27, v238
    v_lshlrev_b32 v190, 16, v239
    v_and_b32 v191, s27, v239
    v_pk_add_f32 v[64:65], v[176:177], v[178:179]
    v_pk_mul_f32 v[66:67], v[176:177], v[176:177]
    v_pk_fma_f32 v[66:67], v[178:179], v[178:179], v[66:67]
    v_pk_add_f32 v[64:65], v[64:65], v[180:181]
    v_pk_fma_f32 v[66:67], v[180:181], v[180:181], v[66:67]
    v_pk_add_f32 v[64:65], v[64:65], v[182:183]
    v_pk_fma_f32 v[66:67], v[182:183], v[182:183], v[66:67]
    v_pk_add_f32 v[64:65], v[64:65], v[184:185]
    v_pk_fma_f32 v[66:67], v[184:185], v[184:185], v[66:67]
    v_pk_add_f32 v[64:65], v[64:65], v[186:187]
    v_pk_fma_f32 v[66:67], v[186:187], v[186:187], v[66:67]
    v_pk_add_f32 v[64:65], v[64:65], v[188:189]
    v_pk_fma_f32 v[66:67], v[188:189], v[188:189], v[66:67]
    v_pk_add_f32 v[64:65], v[64:65], v[190:191]
    v_pk_fma_f32 v[66:67], v[190:191], v[190:191], v[66:67]
    v_add_f32 v68, v64, v65
    v_add_f32 v69, v66, v67
    s_nop 0
    v_add_f32_dpp v68, v68, v68 row_shr:1 row_mask:0xf bank_mask:0xf bound_ctrl:0
    v_add_f32_dpp v69, v69, v69 row_shr:1 row_mask:0xf bank_mask:0xf bound_ctrl:0
    s_nop 0
    v_add_f32_dpp v68, v68, v68 row_shr:2 row_mask:0xf bank_mask:0xf bound_ctrl:0
    v_add_f32_dpp v69, v69, v69 row_shr:2 row_mask:0xf bank_mask:0xf bound_ctrl:0
    s_nop 0
    v_add_f32_dpp v68, v68, v68 row_shr:4 row_mask:0xf bank_mask:0xf bound_ctrl:0
    v_add_f32_dpp v69, v69, v69 row_shr:4 row_mask:0xf bank_mask:0xf bound_ctrl:0
    s_nop 0
    v_add_f32_dpp v68, v68, v68 row_shr:8 row_mask:0xf bank_mask:0xf bound_ctrl:0
    v_add_f32_dpp v69, v69, v69 row_shr:8 row_mask:0xf bank_mask:0xf bound_ctrl:0
    s_nop 0
    v_add_f32_dpp v68, v68, v68 row_bcast:15 row_mask:0xa bank_mask:0xf
    v_add_f32_dpp v69, v69, v69 row_bcast:15 row_mask:0xa bank_mask:0xf
    s_nop 0
    v_add_f32_dpp v68, v68, v68 row_bcast:31 row_mask:0xc bank_mask:0xf
    v_add_f32_dpp v69, v69, v69 row_bcast:31 row_mask:0xc bank_mask:0xf
    s_nop 0
    v_readlane_b32 s52, v68, 63
    v_readlane_b32 s53, v69, 63
    v_mov_b32 v66, 0x3a800000
    s_nop 0
    v_mul_f32 v64, s52, v66
    v_mul_f32 v65, s53, v66
    v_fma_f32 v65, -v64, v64, v65
    v_max_f32 v65, 0, v65
    v_add_f32 v65, 0x3727c5ac, v65
    v_rsq_f32 v192, v65
    s_nop 0
    v_mul_f32 v194, -v64, v192
    s_waitcnt vmcnt(11)
    v_lshlrev_b32 v8, 16, v120
    v_and_b32 v9, s27, v120
    v_pk_fma_f32 v[16:17], v[8:9], v[40:41], v[16:17] op_sel_hi:[1,0,1]
    v_lshlrev_b32 v10, 16, v121
    v_and_b32 v11, s27, v121
    v_pk_fma_f32 v[18:19], v[10:11], v[40:41], v[18:19] op_sel_hi:[1,0,1]
    v_lshlrev_b32 v8, 16, v122
    v_and_b32 v9, s27, v122
    v_pk_fma_f32 v[20:21], v[8:9], v[40:41], v[20:21] op_sel_hi:[1,0,1]
    v_lshlrev_b32 v10, 16, v123
    v_and_b32 v11, s27, v123
    v_pk_fma_f32 v[22:23], v[10:11], v[40:41], v[22:23] op_sel_hi:[1,0,1]
    s_waitcnt vmcnt(10)
    v_lshlrev_b32 v8, 16, v124
    v_and_b32 v9, s27, v124
    v_pk_fma_f32 v[16:17], v[8:9], v[42:43], v[16:17] op_sel_hi:[1,0,1]
    v_lshlrev_b32 v10, 16, v125
    v_and_b32 v11, s27, v125
    v_pk_fma_f32 v[18:19], v[10:11], v[42:43], v[18:19] op_sel_hi:[1,0,1]
    v_lshlrev_b32 v8, 16, v126
    v_and_b32 v9, s27, v126
    v_pk_fma_f32 v[20:21], v[8:9], v[42:43], v[20:21] op_sel_hi:[1,0,1]
    v_lshlrev_b32 v10, 16, v127
    v_and_b32 v11, s27, v127
    v_pk_fma_f32 v[22:23], v[10:11], v[42:43], v[22:23] op_sel_hi:[1,0,1]
    s_waitcnt vmcnt(9)
    v_lshlrev_b32 v8, 16, v128
    v_and_b32 v9, s27, v128
    v_pk_fma_f32 v[16:17], v[8:9], v[44:45], v[16:17] op_sel_hi:[1,0,1]
    v_lshlrev_b32 v10, 16, v129
    v_and_b32 v11, s27, v129
    v_pk_fma_f32 v[18:19], v[10:11], v[44:45], v[18:19] op_sel_hi:[1,0,1]
    v_lshlrev_b32 v8, 16, v130
    v_and_b32 v9, s27, v130
    v_pk_fma_f32 v[20:21], v[8:9], v[44:45], v[20:21] op_sel_hi:[1,0,1]
    v_lshlrev_b32 v10, 16, v131
    v_and_b32 v11, s27, v131
    v_pk_fma_f32 v[22:23], v[10:11], v[44:45], v[22:23] op_sel_hi:[1,0,1]
    s_waitcnt vmcnt(8)
    v_lshlrev_b32 v8, 16, v132
    v_and_b32 v9, s27, v132
    v_pk_fma_f32 v[16:17], v[8:9], v[46:47], v[16:17] op_sel_hi:[1,0,1]
    v_lshlrev_b32 v10, 16, v133
    v_and_b32 v11, s27, v133
    v_pk_fma_f32 v[18:19], v[10:11], v[46:47], v[18:19] op_sel_hi:[1,0,1]
    v_lshlrev_b32 v8, 16, v134
    v_and_b32 v9, s27, v134
    v_pk_fma_f32 v[20:21], v[8:9], v[46:47], v[20:21] op_sel_hi:[1,0,1]
    v_lshlrev_b32 v10, 16, v135
    v_and_b32 v11, s27, v135
    v_pk_fma_f32 v[22:23], v[10:11], v[46:47], v[22:23] op_sel_hi:[1,0,1]
    s_waitcnt vmcnt(7)
    v_lshlrev_b32 v8, 16, v136
    v_and_b32 v9, s27, v136
    v_pk_fma_f32 v[16:17], v[8:9], v[48:49], v[16:17] op_sel_hi:[1,0,1]
    v_lshlrev_b32 v10, 16, v137
    v_and_b32 v11, s27, v137
    v_pk_fma_f32 v[18:19], v[10:11], v[48:49], v[18:19] op_sel_hi:[1,0,1]
    v_lshlrev_b32 v8, 16, v138
    v_and_b32 v9, s27, v138
    v_pk_fma_f32 v[20:21], v[8:9], v[48:49], v[20:21] op_sel_hi:[1,0,1]
    v_lshlrev_b32 v10, 16, v139
    v_and_b32 v11, s27, v139
    v_pk_fma_f32 v[22:23], v[10:11], v[48:49], v[22:23] op_sel_hi:[1,0,1]
    s_waitcnt vmcnt(6)
    v_lshlrev_b32 v8, 16, v140
    v_and_b32 v9, s27, v140
    v_pk_fma_f32 v[16:17], v[8:9], v[50:51], v[16:17] op_sel_hi:[1,0,1]
    v_lshlrev_b32 v10, 16, v141
    v_and_b32 v11, s27, v141
    v_pk_fma_f32 v[18:19], v[10:11], v[50:51], v[18:19] op_sel_hi:[1,0,1]
    v_lshlrev_b32 v8, 16, v142
    v_and_b32 v9, s27, v142
    v_pk_fma_f32 v[20:21], v[8:9], v[50:51], v[20:21] op_sel_hi:[1,0,1]
    v_lshlrev_b32 v10, 16, v143
    v_and_b32 v11, s27, v143
    v_pk_fma_f32 v[22:23], v[10:11], v[50:51], v[22:23] op_sel_hi:[1,0,1]
    s_waitcnt vmcnt(5)
    v_lshlrev_b32 v8, 16, v144
    v_and_b32 v9, s27, v144
    v_pk_fma_f32 v[16:17], v[8:9], v[52:53], v[16:17] op_sel_hi:[1,0,1]
    v_lshlrev_b32 v10, 16, v145
    v_and_b32 v11, s27, v145
    v_pk_fma_f32 v[18:19], v[10:11], v[52:53], v[18:19] op_sel_hi:[1,0,1]
    v_lshlrev_b32 v8, 16, v146
    v_and_b32 v9, s27, v146
    v_pk_fma_f32 v[20:21], v[8:9], v[52:53], v[20:21] op_sel_hi:[1,0,1]
    v_lshlrev_b32 v10, 16, v147
    v_and_b32 v11, s27, v147
    v_pk_fma_f32 v[22:23], v[10:11], v[52:53], v[22:23] op_sel_hi:[1,0,1]
    s_waitcnt vmcnt(4)
    v_lshlrev_b32 v8, 16, v148
    v_and_b32 v9, s27, v148
    v_pk_fma_f32 v[16:17], v[8:9], v[54:55], v[16:17] op_sel_hi:[1,0,1]
    v_lshlrev_b32 v10, 16, v149
    v_and_b32 v11, s27, v149
    v_pk_fma_f32 v[18:19], v[10:11], v[54:55], v[18:19] op_sel_hi:[1,0,1]
    v_lshlrev_b32 v8, 16, v150
    v_and_b32 v9, s27, v150
    v_pk_fma_f32 v[20:21], v[8:9], v[54:55], v[20:21] op_sel_hi:[1,0,1]
    v_lshlrev_b32 v10, 16, v151
    v_and_b32 v11, s27, v151
    v_pk_fma_f32 v[22:23], v[10:11], v[54:55], v[22:23] op_sel_hi:[1,0,1]
    s_waitcnt vmcnt(3)
    v_lshlrev_b32 v8, 16, v152
    v_and_b32 v9, s27, v152
    v_pk_fma_f32 v[16:17], v[8:9], v[56:57], v[16:17] op_sel_hi:[1,0,1]
    v_lshlrev_b32 v10, 16, v153
    v_and_b32 v11, s27, v153
    v_pk_fma_f32 v[18:19], v[10:11], v[56:57], v[18:19] op_sel_hi:[1,0,1]
    v_lshlrev_b32 v8, 16, v154
    v_and_b32 v9, s27, v154
    v_pk_fma_f32 v[20:21], v[8:9], v[56:57], v[20:21] op_sel_hi:[1,0,1]
    v_lshlrev_b32 v10, 16, v155
    v_and_b32 v11, s27, v155
    v_pk_fma_f32 v[22:23], v[10:11], v[56:57], v[22:23] op_sel_hi:[1,0,1]
    s_waitcnt vmcnt(2)
    v_lshlrev_b32 v8, 16, v156
    v_and_b32 v9, s27, v156
    v_pk_fma_f32 v[16:17], v[8:9], v[58:59], v[16:17] op_sel_hi:[1,0,1]
    v_lshlrev_b32 v10, 16, v157
    v_and_b32 v11, s27, v157
    v_pk_fma_f32 v[18:19], v[10:11], v[58:59], v[18:19] op_sel_hi:[1,0,1]
    v_lshlrev_b32 v8, 16, v158
    v_and_b32 v9, s27, v158
    v_pk_fma_f32 v[20:21], v[8:9], v[58:59], v[20:21] op_sel_hi:[1,0,1]
    v_lshlrev_b32 v10, 16, v159
    v_and_b32 v11, s27, v159
    v_pk_fma_f32 v[22:23], v[10:11], v[58:59], v[22:23] op_sel_hi:[1,0,1]
    s_waitcnt vmcnt(1)
    v_lshlrev_b32 v8, 16, v160
    v_and_b32 v9, s27, v160
    v_pk_fma_f32 v[16:17], v[8:9], v[60:61], v[16:17] op_sel_hi:[1,0,1]
    v_lshlrev_b32 v10, 16, v161
    v_and_b32 v11, s27, v161
    v_pk_fma_f32 v[18:19], v[10:11], v[60:61], v[18:19] op_sel_hi:[1,0,1]
    v_lshlrev_b32 v8, 16, v162
    v_and_b32 v9, s27, v162
    v_pk_fma_f32 v[20:21], v[8:9], v[60:61], v[20:21] op_sel_hi:[1,0,1]
    v_lshlrev_b32 v10, 16, v163
    v_and_b32 v11, s27, v163
    v_pk_fma_f32 v[22:23], v[10:11], v[60:61], v[22:23] op_sel_hi:[1,0,1]
    s_waitcnt vmcnt(0)
    v_lshlrev_b32 v8, 16, v164
    v_and_b32 v9, s27, v164
    v_pk_fma_f32 v[16:17], v[8:9], v[62:63], v[16:17] op_sel_hi:[1,0,1]
    v_lshlrev_b32 v10, 16, v165
    v_and_b32 v11, s27, v165
    v_pk_fma_f32 v[18:19], v[10:11], v[62:63], v[18:19] op_sel_hi:[1,0,1]
    v_lshlrev_b32 v8, 16, v166
    v_and_b32 v9, s27, v166
    v_pk_fma_f32 v[20:21], v[8:9], v[62:63], v[20:21] op_sel_hi:[1,0,1]
    v_lshlrev_b32 v10, 16, v167
    v_and_b32 v11, s27, v167
    v_pk_fma_f32 v[22:23], v[10:11], v[62:63], v[22:23] op_sel_hi:[1,0,1]
    s_nop 1
    v_add_f32_dpp v16, v16, v16 row_ror:8 row_mask:0xf bank_mask:0xf
    v_add_f32_dpp v17, v17, v17 row_ror:8 row_mask:0xf bank_mask:0xf
    v_add_f32_dpp v18, v18, v18 row_ror:8 row_mask:0xf bank_mask:0xf
    v_add_f32_dpp v19, v19, v19 row_ror:8 row_mask:0xf bank_mask:0xf
    v_add_f32_dpp v20, v20, v20 row_ror:8 row_mask:0xf bank_mask:0xf
    v_add_f32_dpp v21, v21, v21 row_ror:8 row_mask:0xf bank_mask:0xf
    v_add_f32_dpp v22, v22, v22 row_ror:8 row_mask:0xf bank_mask:0xf
    v_add_f32_dpp v23, v23, v23 row_ror:8 row_mask:0xf bank_mask:0xf
    v_mov_b32 v24, v16
    v_mov_b32 v25, v17
    v_mov_b32 v26, v18
    v_mov_b32 v27, v19
    v_mov_b32 v28, v20
    v_mov_b32 v29, v21
    v_mov_b32 v30, v22
    v_mov_b32 v31, v23
    v_permlane16_swap_b32 v16, v24
    v_permlane16_swap_b32 v17, v25
    v_permlane16_swap_b32 v18, v26
    v_permlane16_swap_b32 v19, v27
    v_permlane16_swap_b32 v20, v28
    v_permlane16_swap_b32 v21, v29
    v_permlane16_swap_b32 v22, v30
    v_permlane16_swap_b32 v23, v31
    v_add_f32 v16, v16, v24
    v_add_f32 v17, v17, v25
    v_add_f32 v18, v18, v26
    v_add_f32 v19, v19, v27
    v_add_f32 v20, v20, v28
    v_add_f32 v21, v21, v29
    v_add_f32 v22, v22, v30
    v_add_f32 v23, v23, v31
    v_mov_b32 v24, v16
    v_mov_b32 v25, v17
    v_mov_b32 v26, v18
    v_mov_b32 v27, v19
    v_mov_b32 v28, v20
    v_mov_b32 v29, v21
    v_mov_b32 v30, v22
    v_mov_b32 v31, v23
    v_permlane32_swap_b32 v16, v24
    v_permlane32_swap_b32 v17, v25
    v_permlane32_swap_b32 v18, v26
    v_permlane32_swap_b32 v19, v27
    v_permlane32_swap_b32 v20, v28
    v_permlane32_swap_b32 v21, v29
    v_permlane32_swap_b32 v22, v30
    v_permlane32_swap_b32 v23, v31
    v_add_f32 v16, v16, v24
    v_add_f32 v17, v17, v25
    v_add_f32 v18, v18, v26
    v_add_f32 v19, v19, v27
    v_add_f32 v20, v20, v28
    v_add_f32 v21, v21, v29
    v_add_f32 v22, v22, v30
    v_add_f32 v23, v23, v31
    s_lshl_b32 s25, s63, 8
    s_add_u32 s25, s25, 97280
    v_and_b32 v8, 7, v2
    v_lshlrev_b32 v8, 5, v8
    v_add_u32 v8, s25, v8
    ds_write_b128 v8, v[16:19]
    ds_write_b128 v8, v[20:23] offset:16
    v_mov_b32 v9, 161796
    v_mov_b32 v10, 1
    s_waitcnt lgkmcnt(0)
    ds_add_rtn_u32 v10, v9, v10
    s_waitcnt lgkmcnt(0)
    v_cmp_le_u32 vcc, 192, v10
    s_nop 1
    s_cbranch_vccz f1_kernel_Lj
    v_lshlrev_b32 v8, 2, v2
    v_add_u32 v9, 97280, v8
    ds_read_b32 v16, v9 offset:0
    ds_read_b32 v17, v9 offset:256
    ds_read_b32 v18, v9 offset:512
    ds_read_b32 v19, v9 offset:768
    s_add_u32 s16, s4, 0x2000000
    s_addc_u32 s17, s5, 0
    s_mov_b32 s18, 0xc000
    s_mov_b32 s19, 0x20000
    s_and_b32 s25, s2, 1
    s_mul_i32 s25, s25, 24576
    s_lshl_b32 s26, s36, 8
    s_add_u32 s25, s25, s26
    s_waitcnt lgkmcnt(0)
    v_add_f32 v16, v16, v17
    v_add_f32 v18, v18, v19
    v_add_f32 v16, v16, v18
    buffer_store_dword v16, v8, s[16:19], s25 offen sc0 sc1
    s_lshl_b32 s25, s2, 7
    s_add_u32 s25, s25, 294912
    s_waitcnt vmcnt(0)
    s_mov_b64 exec, 1
    buffer_store_dword v13, off, s[56:59], s25 sc0 sc1
    s_mov_b64 exec, -1
    s_branch f1_kernel_Lj
f1_kernel_Lidle:
    v_lshrrev_b32 v166, 3, v2
    v_and_b32 v175, 7, v2
    v_xor_b32 v175, v175, v166
    v_lshlrev_b32 v175, 4, v175
    v_lshl_add_u32 v175, v166, 11, v175
    s_mul_i32 s52, s63, 448
    v_add_u32 v162, s52, v2
    s_movk_i32 s52, 2341
    s_movk_i32 s53, 7168
    v_add_u32 v163, 0, v162
    v_mul_u32_u24 v164, s52, v163
    v_lshrrev_b32 v164, 16, v164
    v_mul_u32_u24 v165, 28, v164
    v_sub_u32 v163, v163, v165
    v_bfe_u32 v165, v164, 3, 1
    v_lshlrev_b32 v165, 1, v165
    v_xor_b32 v163, v163, v165
    v_mul_u32_u24 v164, s53, v164
    v_lshl_add_u32 v168, v163, 4, v164
    v_add_u32 v163, 64, v162
    v_mul_u32_u24 v164, s52, v163
    v_lshrrev_b32 v164, 16, v164
    v_mul_u32_u24 v165, 28, v164
    v_sub_u32 v163, v163, v165
    v_bfe_u32 v165, v164, 3, 1
    v_lshlrev_b32 v165, 1, v165
    v_xor_b32 v163, v163, v165
    v_mul_u32_u24 v164, s53, v164
    v_lshl_add_u32 v169, v163, 4, v164
    v_add_u32 v163, 128, v162
    v_mul_u32_u24 v164, s52, v163
    v_lshrrev_b32 v164, 16, v164
    v_mul_u32_u24 v165, 28, v164
    v_sub_u32 v163, v163, v165
    v_bfe_u32 v165, v164, 3, 1
    v_lshlrev_b32 v165, 1, v165
    v_xor_b32 v163, v163, v165
    v_mul_u32_u24 v164, s53, v164
    v_lshl_add_u32 v170, v163, 4, v164
    v_add_u32 v163, 192, v162
    v_mul_u32_u24 v164, s52, v163
    v_lshrrev_b32 v164, 16, v164
    v_mul_u32_u24 v165, 28, v164
    v_sub_u32 v163, v163, v165
    v_bfe_u32 v165, v164, 3, 1
    v_lshlrev_b32 v165, 1, v165
    v_xor_b32 v163, v163, v165
    v_mul_u32_u24 v164, s53, v164
    v_lshl_add_u32 v171, v163, 4, v164
    v_add_u32 v163, 256, v162
    v_mul_u32_u24 v164, s52, v163
    v_lshrrev_b32 v164, 16, v164
    v_mul_u32_u24 v165, 28, v164
    v_sub_u32 v163, v163, v165
    v_bfe_u32 v165, v164, 3, 1
    v_lshlrev_b32 v165, 1, v165
    v_xor_b32 v163, v163, v165
    v_mul_u32_u24 v164, s53, v164
    v_lshl_add_u32 v172, v163, 4, v164
    v_add_u32 v163, 320, v162
    v_mul_u32_u24 v164, s52, v163
    v_lshrrev_b32 v164, 16, v164
    v_mul_u32_u24 v165, 28, v164
    v_sub_u32 v163, v163, v165
    v_bfe_u32 v165, v164, 3, 1
    v_lshlrev_b32 v165, 1, v165
    v_xor_b32 v163, v163, v165
    v_mul_u32_u24 v164, s53, v164
    v_lshl_add_u32 v173, v163, 4, v164
    v_add_u32 v163, 384, v162
    v_mul_u32_u24 v164, s52, v163
    v_lshrrev_b32 v164, 16, v164
    v_mul_u32_u24 v165, 28, v164
    v_sub_u32 v163, v163, v165
    v_bfe_u32 v165, v164, 3, 1
    v_lshlrev_b32 v165, 1, v165
    v_xor_b32 v163, v163, v165
    v_mul_u32_u24 v164, s53, v164
    v_lshl_add_u32 v174, v163, 4, v164
f1_kernel_gk2:
    ds_read_b32 v15, v14 offset:8
    s_waitcnt lgkmcnt(0)
    v_cmp_ne_u32 vcc, 256, v15
    s_nop 1
    s_cbranch_vccnz f1_kernel_gk2
    s_mov_b32 s8, s6
    s_mov_b32 s9, s7
    s_mov_b32 s10, 0x400000
    s_mov_b32 s11, 0x20000
    buffer_load_dwordx4 v[232:235], v3, s[8:11], s61 offen offset:0 nt
    buffer_load_dwordx4 v[236:239], v3, s[8:11], s61 offen offset:1024 nt
    s_getpc_b64 s[46:47]
f1_kernel_ct2:
    s_sub_u32 s46, s46, f1_kernel_ct2-f1_kernel
    s_subb_u32 s47, s47, 0
    s_lshr_b32 s44, s2, 3
    s_lshl_b32 s44, s44, 2
    s_add_u32 s44, s44, s63
    s_mul_i32 s44, s44, 320
    s_min_u32 s44, s44, code_end-f1_kernel-320
    s_add_u32 s46, s46, s44
    s_addc_u32 s47, s47, 0
    s_load_dword s45, s[46:47], 0
    s_load_dword s45, s[46:47], 64
    s_load_dword s45, s[46:47], 128
    s_load_dword s45, s[46:47], 192
    s_load_dword s45, s[46:47], 256
    s_waitcnt vmcnt(0)
    s_lshr_b32 s52, s20, 1
    v_lshrrev_b32 v196, 1, v2
    v_xor_b32 v196, s52, v196
    v_and_b32 v196, 3, v196
    v_lshlrev_b32 v196, 4, v196
    v_lshl_add_u32 v196, v2, 7, v196
    s_and_b32 s52, s20, 1
    s_lshl_b32 s52, s52, 3
    s_add_u32 s52, s52, 135168
    v_add_u32 v196, s52, v196
    v_add_u32 v197, 151552, v3
    v_lshlrev_b32 v176, 16, v232
    v_and_b32 v177, s27, v232
    v_lshlrev_b32 v178, 16, v233
    v_and_b32 v179, s27, v233
    v_lshlrev_b32 v180, 16, v234
    v_and_b32 v181, s27, v234
    v_lshlrev_b32 v182, 16, v235
    v_and_b32 v183, s27, v235
    v_lshlrev_b32 v184, 16, v236
    v_and_b32 v185, s27, v236
    v_lshlrev_b32 v186, 16, v237
    v_and_b32 v187, s27, v237
    v_lshlrev_b32 v188, 16, v238
    v_and_b32 v189, s27, v238
    v_lshlrev_b32 v190, 16, v239
    v_and_b32 v191, s27, v239
    v_pk_add_f32 v[64:65], v[176:177], v[178:179]
    v_pk_mul_f32 v[66:67], v[176:177], v[176:177]
    v_pk_fma_f32 v[66:67], v[178:179], v[178:179], v[66:67]
    v_pk_add_f32 v[64:65], v[64:65], v[180:181]
    v_pk_fma_f32 v[66:67], v[180:181], v[180:181], v[66:67]
    v_pk_add_f32 v[64:65], v[64:65], v[182:183]
    v_pk_fma_f32 v[66:67], v[182:183], v[182:183], v[66:67]
    v_pk_add_f32 v[64:65], v[64:65], v[184:185]
    v_pk_fma_f32 v[66:67], v[184:185], v[184:185], v[66:67]
    v_pk_add_f32 v[64:65], v[64:65], v[186:187]
    v_pk_fma_f32 v[66:67], v[186:187], v[186:187], v[66:67]
    v_pk_add_f32 v[64:65], v[64:65], v[188:189]
    v_pk_fma_f32 v[66:67], v[188:189], v[188:189], v[66:67]
    v_pk_add_f32 v[64:65], v[64:65], v[190:191]
    v_pk_fma_f32 v[66:67], v[190:191], v[190:191], v[66:67]
    v_add_f32 v68, v64, v65
    v_add_f32 v69, v66, v67
    s_nop 0
    v_add_f32_dpp v68, v68, v68 row_shr:1 row_mask:0xf bank_mask:0xf bound_ctrl:0
    v_add_f32_dpp v69, v69, v69 row_shr:1 row_mask:0xf bank_mask:0xf bound_ctrl:0
    s_nop 0
    v_add_f32_dpp v68, v68, v68 row_shr:2 row_mask:0xf bank_mask:0xf bound_ctrl:0
    v_add_f32_dpp v69, v69, v69 row_shr:2 row_mask:0xf bank_mask:0xf bound_ctrl:0
    s_nop 0
    v_add_f32_dpp v68, v68, v68 row_shr:4 row_mask:0xf bank_mask:0xf bound_ctrl:0
    v_add_f32_dpp v69, v69, v69 row_shr:4 row_mask:0xf bank_mask:0xf bound_ctrl:0
    s_nop 0
    v_add_f32_dpp v68, v68, v68 row_shr:8 row_mask:0xf bank_mask:0xf bound_ctrl:0
    v_add_f32_dpp v69, v69, v69 row_shr:8 row_mask:0xf bank_mask:0xf bound_ctrl:0
    s_nop 0
    v_add_f32_dpp v68, v68, v68 row_bcast:15 row_mask:0xa bank_mask:0xf
    v_add_f32_dpp v69, v69, v69 row_bcast:15 row_mask:0xa bank_mask:0xf
    s_nop 0
    v_add_f32_dpp v68, v68, v68 row_bcast:31 row_mask:0xc bank_mask:0xf
    v_add_f32_dpp v69, v69, v69 row_bcast:31 row_mask:0xc bank_mask:0xf
    s_nop 0
    v_readlane_b32 s52, v68, 63
    v_readlane_b32 s53, v69, 63
    v_mov_b32 v66, 0x3a800000
    s_nop 0
    v_mul_f32 v64, s52, v66
    v_mul_f32 v65, s53, v66
    v_fma_f32 v65, -v64, v64, v65
    v_max_f32 v65, 0, v65
    v_add_f32 v65, 0x3727c5ac, v65
    v_rsq_f32 v192, v65
    s_nop 0
    v_mul_f32 v194, -v64, v192
    s_mov_b32 s12, s70
    s_mov_b32 s13, s71
    s_mov_b32 s14, 0x310000
    s_mov_b32 s15, 0x20000
    s_sub_u32 s30, s2, 192
    s_lshl_b32 s30, s30, 2
    s_add_u32 s30, s30, s63
    s_mul_i32 s30, s30, 12544
    v_lshlrev_b32 v11, 7, v2
    buffer_load_dword v12, v11, s[12:15], s30 offen
    s_add_u32 s30, s30, 8192
    v_min_u32 v11, 4224, v11
    buffer_load_dword v12, v11, s[12:15], s30 offen
    s_add_u32 s30, s30, 8192
f1_kernel_Lj:
    s_waitcnt lgkmcnt(0)
    v_lshlrev_b32 v4, 7, v2
    v_add_u32 v4, 294912, v4
    s_add_u32 s16, s4, 0x2000000
    s_addc_u32 s17, s5, 0
    s_mov_b32 s18, 0xc000
    s_mov_b32 s19, 0x20000
    v_and_b32 v7, 0xff, v0
    v_lshlrev_b32 v6, 3, v7
    v_add_u32 v6, 151552, v6
    v_lshlrev_b32 v7, 4, v7
    s_bfe_u32 s80, s2, 0x20001
    s_lshl_b32 s80, s80, 2
    s_lshr_b32 s22, s2, 6
    s_add_u32 s80, s80, s22
    s_mul_i32 s80, s80, 448
    s_mul_i32 s81, s63, 7168
    s_mov_b32 s8, s70
    s_mov_b32 s9, s71
    s_mov_b32 s10, 0x700000
    s_mov_b32 s11, 0x20000
f1_kernel_pfy:
    ds_read_b32 v15, v14 offset:28
    s_waitcnt lgkmcnt(0)
    v_cmp_ne_u32 vcc, 4, v15
    s_sleep 1
    s_cbranch_vccnz f1_kernel_pfy
    s_add_u32 m0, s81, 0
    s_nop 0
    buffer_load_dwordx4 v168, s[8:11], s80 offen lds
    s_add_u32 m0, s81, 1024
    s_nop 0
    buffer_load_dwordx4 v169, s[8:11], s80 offen lds
    s_add_u32 m0, s81, 2048
    s_nop 0
    buffer_load_dwordx4 v170, s[8:11], s80 offen lds
    s_add_u32 m0, s81, 3072
    s_nop 0
    buffer_load_dwordx4 v171, s[8:11], s80 offen lds
    s_add_u32 m0, s81, 4096
    s_nop 0
    buffer_load_dwordx4 v172, s[8:11], s80 offen lds
    s_add_u32 m0, s81, 5120
    s_nop 0
    buffer_load_dwordx4 v173, s[8:11], s80 offen lds
    s_add_u32 m0, s81, 6144
    s_nop 0
    buffer_load_dwordx4 v174, s[8:11], s80 offen lds
    s_add_u32 s80, s80, 458752
    s_add_u32 m0, s81, 28672
    s_nop 0
    buffer_load_dwordx4 v168, s[8:11], s80 offen lds
    s_add_u32 m0, s81, 29696
    s_nop 0
    buffer_load_dwordx4 v169, s[8:11], s80 offen lds
    s_add_u32 m0, s81, 30720
    s_nop 0
    buffer_load_dwordx4 v170, s[8:11], s80 offen lds
    s_add_u32 m0, s81, 31744
    s_nop 0
    buffer_load_dwordx4 v171, s[8:11], s80 offen lds
    s_add_u32 m0, s81, 32768
    s_nop 0
    buffer_load_dwordx4 v172, s[8:11], s80 offen lds
    s_add_u32 m0, s81, 33792
    s_nop 0
    buffer_load_dwordx4 v173, s[8:11], s80 offen lds
    s_add_u32 m0, s81, 34816
    s_nop 0
    buffer_load_dwordx4 v174, s[8:11], s80 offen lds
    s_add_u32 s80, s80, 458752
    s_cmp_lg_u32 s63, 0
    s_cbranch_scc1 f1_kernel_pmw
    s_mov_b32 s39, 0x40000
    s_mov_b64 s[44:45], -1
    s_mov_b64 s[46:47], -1
    v_add_u32 v21, 8192, v4
    s_mov_b64 s[52:53], -1
    v_add_u32 v22, 16384, v4
    s_branch f1_kernel_pm_in
f1_kernel_pm:
    s_sleep 2
f1_kernel_pm_in:
    s_or_b64 exec, s[44:45], 1
    buffer_load_dword v16, v4, s[56:59], 0 offen sc0 sc1
    s_or_b64 exec, s[46:47], 1
    buffer_load_dword v17, v21, s[56:59], 0 offen sc0 sc1
    s_or_b64 exec, s[52:53], 1
    buffer_load_dword v18, v22, s[56:59], 0 offen sc0 sc1
    s_sub_u32 s39, s39, 1
    s_cmp_eq_u32 s39, 0
    s_cbranch_scc1 f1_kernel_pm_out
    s_waitcnt vmcnt(0)
    s_or_b64 exec, s[44:45], 1
    v_cmp_ne_u32 s[44:45], s83, v16
    s_or_b64 exec, s[46:47], 1
    v_cmp_ne_u32 s[46:47], s83, v17
    s_or_b64 exec, s[52:53], 1
    v_cmp_ne_u32 s[52:53], s83, v18
    s_nop 1
    s_or_b64 vcc, s[44:45], s[46:47]
    s_or_b64 vcc, vcc, s[52:53]
    s_cbranch_scc1 f1_kernel_pm
f1_kernel_pm_out:
    s_mov_b64 exec, -1
    v_mov_b32 v15, 1
    ds_write_b32 v14, v15 offset:12
f1_kernel_pmw:
    ds_read_b32 v15, v14 offset:12
    s_waitcnt lgkmcnt(0)
    v_cmp_ne_u32 vcc, 1, v15
    s_sleep 1
    s_cbranch_vccnz f1_kernel_pmw
    s_mov_b32 s22, 0
    buffer_load_dwordx4 v[32:35], v7, s[16:19], s22 offen sc0 sc1
    s_mov_b32 s22, 24576
    buffer_load_dwordx4 v[36:39], v7, s[16:19], s22 offen sc0 sc1
    s_mov_b32 s22, 4096
    buffer_load_dwordx4 v[40:43], v7, s[16:19], s22 offen sc0 sc1
    s_mov_b32 s22, 28672
    buffer_load_dwordx4 v[44:47], v7, s[16:19], s22 offen sc0 sc1
    s_mov_b32 s22, 8192
    buffer_load_dwordx4 v[48:51], v7, s[16:19], s22 offen sc0 sc1
    s_mov_b32 s22, 32768
    buffer_load_dwordx4 v[52:55], v7, s[16:19], s22 offen sc0 sc1
    s_mov_b32 s22, 12288
    buffer_load_dwordx4 v[56:59], v7, s[16:19], s22 offen sc0 sc1
    s_mov_b32 s22, 36864
    buffer_load_dwordx4 v[60:63], v7, s[16:19], s22 offen sc0 sc1
    s_mov_b32 s22, 16384
    buffer_load_dwordx4 v[64:67], v7, s[16:19], s22 offen sc0 sc1
    s_mov_b32 s22, 40960
    buffer_load_dwordx4 v[68:71], v7, s[16:19], s22 offen sc0 sc1
    s_waitcnt vmcnt(8)
    v_pk_add_f32 v[32:33], v[32:33], v[36:37]
    v_pk_add_f32 v[34:35], v[34:35], v[38:39]
    v_cvt_pk_bf16_f32 v36, v32, v33
    v_cvt_pk_bf16_f32 v37, v34, v35
    ds_write_b64 v6, v[36:37] offset:0
    s_waitcnt vmcnt(6)
    v_pk_add_f32 v[40:41], v[40:41], v[44:45]
    v_pk_add_f32 v[42:43], v[42:43], v[46:47]
    v_cvt_pk_bf16_f32 v44, v40, v41
    v_cvt_pk_bf16_f32 v45, v42, v43
    v_lshlrev_b32 v40, 16, v44
    v_and_b32 v41, s27, v44
    v_lshlrev_b32 v42, 16, v45
    v_and_b32 v43, s27, v45
    v_pk_add_f32 v[40:41], v[40:41], 1.0 op_sel_hi:[1,0]
    v_pk_add_f32 v[42:43], v[42:43], 1.0 op_sel_hi:[1,0]
    v_cvt_pk_bf16_f32 v44, v40, v41
    v_cvt_pk_bf16_f32 v45, v42, v43
    ds_write_b64 v6, v[44:45] offset:2048
    s_waitcnt vmcnt(4)
    v_pk_add_f32 v[48:49], v[48:49], v[52:53]
    v_pk_add_f32 v[50:51], v[50:51], v[54:55]
    v_cvt_pk_bf16_f32 v52, v48, v49
    v_cvt_pk_bf16_f32 v53, v50, v51
    ds_write_b64 v6, v[52:53] offset:4096
    s_waitcnt vmcnt(2)
    v_pk_add_f32 v[56:57], v[56:57], v[60:61]
    v_pk_add_f32 v[58:59], v[58:59], v[62:63]
    v_cvt_pk_bf16_f32 v60, v56, v57
    v_cvt_pk_bf16_f32 v61, v58, v59
    ds_write_b64 v6, v[60:61] offset:6144
    s_waitcnt vmcnt(0)
    v_pk_add_f32 v[64:65], v[64:65], v[68:69]
    v_pk_add_f32 v[66:67], v[66:67], v[70:71]
    v_cvt_pk_bf16_f32 v68, v64, v65
    v_cvt_pk_bf16_f32 v69, v66, v67
    v_lshlrev_b32 v64, 16, v68
    v_and_b32 v65, s27, v68
    v_lshlrev_b32 v66, 16, v69
    v_and_b32 v67, s27, v69
    v_pk_add_f32 v[64:65], v[64:65], 1.0 op_sel_hi:[1,0]
    v_pk_add_f32 v[66:67], v[66:67], 1.0 op_sel_hi:[1,0]
    v_cvt_pk_bf16_f32 v68, v64, v65
    v_cvt_pk_bf16_f32 v69, v66, v67
    ds_write_b64 v6, v[68:69] offset:8192
    s_waitcnt lgkmcnt(0)
    s_add_u32 s28, s4, 0xc00000
    s_addc_u32 s29, s5, 0
    s_mov_b32 s30, 0x400000
    s_mov_b32 s31, 0x20000
    s_add_u32 s32, s4, 0x800000
    s_addc_u32 s33, s5, 0
    s_mov_b32 s34, 0x400000
    s_mov_b32 s35, 0x20000
    s_mov_b32 s27, 0xffff0000
    v_pk_fma_f32 v[144:145], v[176:177], v[192:193], v[194:195] op_sel_hi:[1,0,0]
    v_pk_fma_f32 v[146:147], v[178:179], v[192:193], v[194:195] op_sel_hi:[1,0,0]
    v_pk_fma_f32 v[148:149], v[180:181], v[192:193], v[194:195] op_sel_hi:[1,0,0]
    v_pk_fma_f32 v[150:151], v[182:183], v[192:193], v[194:195] op_sel_hi:[1,0,0]
    v_pk_fma_f32 v[152:153], v[184:185], v[192:193], v[194:195] op_sel_hi:[1,0,0]
    v_pk_fma_f32 v[154:155], v[186:187], v[192:193], v[194:195] op_sel_hi:[1,0,0]
    v_pk_fma_f32 v[156:157], v[188:189], v[192:193], v[194:195] op_sel_hi:[1,0,0]
    v_pk_fma_f32 v[158:159], v[190:191], v[192:193], v[194:195] op_sel_hi:[1,0,0]
    s_barrier
    ds_read_b128 v[40:43], v197 offset:2048
    ds_read_b128 v[44:47], v197 offset:3072
    ds_read_b128 v[32:35], v197 offset:0
    ds_read_b128 v[36:39], v197 offset:1024
    ds_read_b128 v[48:51], v197 offset:4096
    ds_read_b128 v[52:55], v197 offset:5120
    ds_read_b128 v[64:67], v197 offset:8192
    ds_read_b128 v[68:71], v197 offset:9216
    ds_read_b128 v[56:59], v197 offset:6144
    ds_read_b128 v[60:63], v197 offset:7168
    s_waitcnt lgkmcnt(6)
    v_lshlrev_b32 v104, 16, v40
    v_and_b32 v105, s27, v40
    v_lshlrev_b32 v88, 16, v32
    v_and_b32 v89, s27, v32
    v_pk_fma_f32 v[144:145], v[144:145], v[104:105], v[88:89]
    v_lshlrev_b32 v106, 16, v41
    v_and_b32 v107, s27, v41
    v_lshlrev_b32 v90, 16, v33
    v_and_b32 v91, s27, v33
    v_pk_fma_f32 v[146:147], v[146:147], v[106:107], v[90:91]
    v_lshlrev_b32 v108, 16, v42
    v_and_b32 v109, s27, v42
    v_lshlrev_b32 v92, 16, v34
    v_and_b32 v93, s27, v34
    v_pk_fma_f32 v[148:149], v[148:149], v[108:109], v[92:93]
    v_lshlrev_b32 v110, 16, v43
    v_and_b32 v111, s27, v43
    v_lshlrev_b32 v94, 16, v35
    v_and_b32 v95, s27, v35
    v_pk_fma_f32 v[150:151], v[150:151], v[110:111], v[94:95]
    v_lshlrev_b32 v112, 16, v44
    v_and_b32 v113, s27, v44
    v_lshlrev_b32 v96, 16, v36
    v_and_b32 v97, s27, v36
    v_pk_fma_f32 v[152:153], v[152:153], v[112:113], v[96:97]
    v_lshlrev_b32 v114, 16, v45
    v_and_b32 v115, s27, v45
    v_lshlrev_b32 v98, 16, v37
    v_and_b32 v99, s27, v37
    v_pk_fma_f32 v[154:155], v[154:155], v[114:115], v[98:99]
    v_lshlrev_b32 v116, 16, v46
    v_and_b32 v117, s27, v46
    v_lshlrev_b32 v100, 16, v38
    v_and_b32 v101, s27, v38
    v_pk_fma_f32 v[156:157], v[156:157], v[116:117], v[100:101]
    v_lshlrev_b32 v118, 16, v47
    v_and_b32 v119, s27, v47
    v_lshlrev_b32 v102, 16, v39
    v_and_b32 v103, s27, v39
    v_pk_fma_f32 v[158:159], v[158:159], v[118:119], v[102:103]
    s_waitcnt lgkmcnt(4)
    v_lshlrev_b32 v120, 16, v48
    v_and_b32 v121, s27, v48
    v_pk_mul_f32 v[144:145], v[144:145], v[120:121]
    v_lshlrev_b32 v122, 16, v49
    v_and_b32 v123, s27, v49
    v_pk_mul_f32 v[146:147], v[146:147], v[122:123]
    v_lshlrev_b32 v124, 16, v50
    v_and_b32 v125, s27, v50
    v_pk_mul_f32 v[148:149], v[148:149], v[124:125]
    v_lshlrev_b32 v126, 16, v51
    v_and_b32 v127, s27, v51
    v_pk_mul_f32 v[150:151], v[150:151], v[126:127]
    v_lshlrev_b32 v128, 16, v52
    v_and_b32 v129, s27, v52
    v_pk_mul_f32 v[152:153], v[152:153], v[128:129]
    v_lshlrev_b32 v130, 16, v53
    v_and_b32 v131, s27, v53
    v_pk_mul_f32 v[154:155], v[154:155], v[130:131]
    v_lshlrev_b32 v132, 16, v54
    v_and_b32 v133, s27, v54
    v_pk_mul_f32 v[156:157], v[156:157], v[132:133]
    v_lshlrev_b32 v134, 16, v55
    v_and_b32 v135, s27, v55
    v_pk_mul_f32 v[158:159], v[158:159], v[134:135]
    s_waitcnt lgkmcnt(0)
    v_lshlrev_b32 v104, 16, v64
    v_and_b32 v105, s27, v64
    v_lshlrev_b32 v88, 16, v56
    v_and_b32 v89, s27, v56
    v_lshlrev_b32 v106, 16, v65
    v_and_b32 v107, s27, v65
    v_lshlrev_b32 v90, 16, v57
    v_and_b32 v91, s27, v57
    v_lshlrev_b32 v108, 16, v66
    v_and_b32 v109, s27, v66
    v_lshlrev_b32 v92, 16, v58
    v_and_b32 v93, s27, v58
    v_lshlrev_b32 v110, 16, v67
    v_and_b32 v111, s27, v67
    v_lshlrev_b32 v94, 16, v59
    v_and_b32 v95, s27, v59
    v_lshlrev_b32 v112, 16, v68
    v_and_b32 v113, s27, v68
    v_lshlrev_b32 v96, 16, v60
    v_and_b32 v97, s27, v60
    v_lshlrev_b32 v114, 16, v69
    v_and_b32 v115, s27, v69
    v_lshlrev_b32 v98, 16, v61
    v_and_b32 v99, s27, v61
    v_lshlrev_b32 v116, 16, v70
    v_and_b32 v117, s27, v70
    v_lshlrev_b32 v100, 16, v62
    v_and_b32 v101, s27, v62
    v_lshlrev_b32 v118, 16, v71
    v_and_b32 v119, s27, v71
    v_lshlrev_b32 v102, 16, v63
    v_and_b32 v103, s27, v63
    s_barrier
    ds_read_b64 v[24:25], v196 offset:0
    ds_read_b64 v[26:27], v196 offset:64
    ds_read_b64 v[28:29], v196 offset:8192
    ds_read_b64 v[30:31], v196 offset:8256
    s_waitcnt lgkmcnt(3)
    v_lshlrev_b32 v136, 16, v24
    v_and_b32 v137, s27, v24
    v_pk_fma_f32 v[144:145], v[144:145], v[136:137], v[176:177]
    v_cvt_pk_bf16_f32 v16, v144, v145
    v_lshlrev_b32 v176, 16, v16
    v_and_b32 v177, s27, v16
    v_lshlrev_b32 v138, 16, v25
    v_and_b32 v139, s27, v25
    v_pk_fma_f32 v[146:147], v[146:147], v[138:139], v[178:179]
    v_cvt_pk_bf16_f32 v17, v146, v147
    v_lshlrev_b32 v178, 16, v17
    v_and_b32 v179, s27, v17
    s_waitcnt lgkmcnt(2)
    v_lshlrev_b32 v136, 16, v26
    v_and_b32 v137, s27, v26
    v_pk_fma_f32 v[148:149], v[148:149], v[136:137], v[180:181]
    v_cvt_pk_bf16_f32 v18, v148, v149
    v_lshlrev_b32 v180, 16, v18
    v_and_b32 v181, s27, v18
    v_lshlrev_b32 v138, 16, v27
    v_and_b32 v139, s27, v27
    v_pk_fma_f32 v[150:151], v[150:151], v[138:139], v[182:183]
    v_cvt_pk_bf16_f32 v19, v150, v151
    v_lshlrev_b32 v182, 16, v19
    v_and_b32 v183, s27, v19
    s_waitcnt lgkmcnt(1)
    v_lshlrev_b32 v136, 16, v28
    v_and_b32 v137, s27, v28
    v_pk_fma_f32 v[152:153], v[152:153], v[136:137], v[184:185]
    v_cvt_pk_bf16_f32 v20, v152, v153
    v_lshlrev_b32 v184, 16, v20
    v_and_b32 v185, s27, v20
    v_lshlrev_b32 v138, 16, v29
    v_and_b32 v139, s27, v29
    v_pk_fma_f32 v[154:155], v[154:155], v[138:139], v[186:187]
    v_cvt_pk_bf16_f32 v21, v154, v155
    v_lshlrev_b32 v186, 16, v21
    v_and_b32 v187, s27, v21
    s_waitcnt lgkmcnt(0)
    v_lshlrev_b32 v136, 16, v30
    v_and_b32 v137, s27, v30
    v_pk_fma_f32 v[156:157], v[156:157], v[136:137], v[188:189]
    v_cvt_pk_bf16_f32 v22, v156, v157
    v_lshlrev_b32 v188, 16, v22
    v_and_b32 v189, s27, v22
    v_lshlrev_b32 v138, 16, v31
    v_and_b32 v139, s27, v31
    v_pk_fma_f32 v[158:159], v[158:159], v[138:139], v[190:191]
    v_cvt_pk_bf16_f32 v23, v158, v159
    v_lshlrev_b32 v190, 16, v23
    v_and_b32 v191, s27, v23
    buffer_store_dwordx4 v[16:19], v3, s[28:31], s61 offen offset:0 sc0 sc1
    buffer_store_dwordx4 v[20:23], v3, s[28:31], s61 offen offset:1024 sc0 sc1
    v_pk_add_f32 v[8:9], v[176:177], v[178:179]
    v_pk_mul_f32 v[10:11], v[176:177], v[176:177]
    v_pk_fma_f32 v[10:11], v[178:179], v[178:179], v[10:11]
    v_pk_add_f32 v[8:9], v[8:9], v[180:181]
    v_pk_fma_f32 v[10:11], v[180:181], v[180:181], v[10:11]
    v_pk_add_f32 v[8:9], v[8:9], v[182:183]
    v_pk_fma_f32 v[10:11], v[182:183], v[182:183], v[10:11]
    v_pk_add_f32 v[8:9], v[8:9], v[184:185]
    v_pk_fma_f32 v[10:11], v[184:185], v[184:185], v[10:11]
    v_pk_add_f32 v[8:9], v[8:9], v[186:187]
    v_pk_fma_f32 v[10:11], v[186:187], v[186:187], v[10:11]
    v_pk_add_f32 v[8:9], v[8:9], v[188:189]
    v_pk_fma_f32 v[10:11], v[188:189], v[188:189], v[10:11]
    v_pk_add_f32 v[8:9], v[8:9], v[190:191]
    v_pk_fma_f32 v[10:11], v[190:191], v[190:191], v[10:11]
    v_add_f32 v12, v8, v9
    v_add_f32 v13, v10, v11
    s_nop 0
    v_add_f32_dpp v12, v12, v12 row_shr:1 row_mask:0xf bank_mask:0xf bound_ctrl:0
    v_add_f32_dpp v13, v13, v13 row_shr:1 row_mask:0xf bank_mask:0xf bound_ctrl:0
    s_nop 0
    v_add_f32_dpp v12, v12, v12 row_shr:2 row_mask:0xf bank_mask:0xf bound_ctrl:0
    v_add_f32_dpp v13, v13, v13 row_shr:2 row_mask:0xf bank_mask:0xf bound_ctrl:0
    s_nop 0
    v_add_f32_dpp v12, v12, v12 row_shr:4 row_mask:0xf bank_mask:0xf bound_ctrl:0
    v_add_f32_dpp v13, v13, v13 row_shr:4 row_mask:0xf bank_mask:0xf bound_ctrl:0
    s_nop 0
    v_add_f32_dpp v12, v12, v12 row_shr:8 row_mask:0xf bank_mask:0xf bound_ctrl:0
    v_add_f32_dpp v13, v13, v13 row_shr:8 row_mask:0xf bank_mask:0xf bound_ctrl:0
    s_nop 0
    v_add_f32_dpp v12, v12, v12 row_bcast:15 row_mask:0xa bank_mask:0xf
    v_add_f32_dpp v13, v13, v13 row_bcast:15 row_mask:0xa bank_mask:0xf
    s_nop 0
    v_add_f32_dpp v12, v12, v12 row_bcast:31 row_mask:0xc bank_mask:0xf
    v_add_f32_dpp v13, v13, v13 row_bcast:31 row_mask:0xc bank_mask:0xf
    s_nop 0
    v_readlane_b32 s52, v12, 63
    v_readlane_b32 s53, v13, 63
    v_mov_b32 v10, 0x3a800000
    s_nop 0
    v_mul_f32 v8, s52, v10
    v_mul_f32 v9, s53, v10
    v_fma_f32 v9, -v8, v8, v9
    v_max_f32 v9, 0, v9
    v_add_f32 v9, 0x3727c5ac, v9
    v_rsq_f32 v192, v9
    s_nop 0
    v_mul_f32 v194, -v8, v192
    v_pk_fma_f32 v[144:145], v[176:177], v[192:193], v[194:195] op_sel_hi:[1,0,0]
    v_pk_fma_f32 v[144:145], v[144:145], v[104:105], v[88:89]
    v_cvt_pk_bf16_f32 v24, v144, v145
    v_pk_fma_f32 v[146:147], v[178:179], v[192:193], v[194:195] op_sel_hi:[1,0,0]
    v_pk_fma_f32 v[146:147], v[146:147], v[106:107], v[90:91]
    v_cvt_pk_bf16_f32 v25, v146, v147
    v_pk_fma_f32 v[148:149], v[180:181], v[192:193], v[194:195] op_sel_hi:[1,0,0]
    v_pk_fma_f32 v[148:149], v[148:149], v[108:109], v[92:93]
    v_cvt_pk_bf16_f32 v26, v148, v149
    v_pk_fma_f32 v[150:151], v[182:183], v[192:193], v[194:195] op_sel_hi:[1,0,0]
    v_pk_fma_f32 v[150:151], v[150:151], v[110:111], v[94:95]
    v_cvt_pk_bf16_f32 v27, v150, v151
    v_pk_fma_f32 v[152:153], v[184:185], v[192:193], v[194:195] op_sel_hi:[1,0,0]
    v_pk_fma_f32 v[152:153], v[152:153], v[112:113], v[96:97]
    v_cvt_pk_bf16_f32 v28, v152, v153
    v_pk_fma_f32 v[154:155], v[186:187], v[192:193], v[194:195] op_sel_hi:[1,0,0]
    v_pk_fma_f32 v[154:155], v[154:155], v[114:115], v[98:99]
    v_cvt_pk_bf16_f32 v29, v154, v155
    v_pk_fma_f32 v[156:157], v[188:189], v[192:193], v[194:195] op_sel_hi:[1,0,0]
    v_pk_fma_f32 v[156:157], v[156:157], v[116:117], v[100:101]
    v_cvt_pk_bf16_f32 v30, v156, v157
    v_pk_fma_f32 v[158:159], v[190:191], v[192:193], v[194:195] op_sel_hi:[1,0,0]
    v_pk_fma_f32 v[158:159], v[158:159], v[118:119], v[102:103]
    v_cvt_pk_bf16_f32 v31, v158, v159
    buffer_store_dwordx4 v[24:27], v3, s[32:35], s61 offen offset:0 sc0 sc1
    buffer_store_dwordx4 v[28:31], v3, s[32:35], s61 offen offset:1024 sc0 sc1
    s_lshl_b32 s22, s21, 10
    v_mov_b32 v8, 161792
    v_mov_b32 v9, 1
    s_waitcnt vmcnt(0)
    s_mov_b64 exec, 1
    ds_add_rtn_u32 v9, v8, v9 offset:20
    s_waitcnt lgkmcnt(0)
    v_cmp_eq_u32 vcc, 7, v9
    v_mov_b32 v9, s83
    s_nop 0
    s_cbranch_vccz f1_kernel_ah2
    buffer_store_dword v9, off, s[56:59], s22 offset:512 sc0 sc1
f1_kernel_ah2:
    s_mov_b64 exec, -1
    s_mov_b32 s34, s22
    s_and_b32 s21, s2, 1
    s_lshl_b32 s21, s21, 3
    s_bfe_u32 s27, s2, 0x30003
    s_add_u32 s21, s21, s27
    s_bfe_u32 s22, s2, 0x20001
    s_lshl_b32 s22, s22, 2
    s_lshr_b32 s27, s2, 6
    s_add_u32 s22, s22, s27
    s_lshl_b32 s24, s21, 4
    s_lshl_b32 s27, s63, 2
    s_add_u32 s24, s24, s27
    v_and_b32 v4, 3, v2
    v_add_u32 v4, s24, v4
    v_lshlrev_b32 v4, 10, v4
    v_add_u32 v4, 512, v4
    s_lshl_b32 s24, s24, 14
    s_lshl_b32 s33, s63, 12
    s_add_u32 s33, s33, 86016
    s_add_u32 s12, s4, 0x800000
    s_addc_u32 s13, s5, 0
    s_mov_b32 s14, 0x400000
    s_mov_b32 s15, 0x20000
    s_lshl_b32 s82, s2, 2
    s_add_u32 s82, s82, s63
    s_mul_i32 s38, s82, 448
    s_add_u32 s38, s38, 3211264
    s_add_u32 s38, s38, s70
    s_addc_u32 s39, s71, 0
    s_lshl_b32 s82, s21, 2
    s_add_u32 s82, s82, s63
    s_and_b32 s54, s82, 31
    s_lshl_b32 s54, s54, 11
    s_and_b32 s61, s22, 7
    s_lshl_b32 s55, s61, 8
    s_add_u32 s54, s54, s55
    s_lshr_b32 s55, s22, 3
    s_mul_i32 s55, s55, 3670016
    s_add_u32 s54, s54, s55
    s_add_u32 s54, s54, s72
    s_addc_u32 s55, s73, 0
    s_mul_i32 s61, s61, 7
    s_lshr_b32 s82, s82, 5
    s_mov_b32 s60, 0x40000
    s_branch f1_kernel_ph_in
f1_kernel_ph:
    s_sleep 1
f1_kernel_ph_in:
    buffer_load_dword v15, v4, s[56:59], 0 offen sc0 sc1
    s_sub_u32 s60, s60, 1
    s_cmp_eq_u32 s60, 0
    s_cbranch_scc1 f1_kernel_ph_out
    s_waitcnt vmcnt(0)
    v_cmp_ne_u32 vcc, s83, v15
    s_nop 1
    s_cbranch_vccnz f1_kernel_ph
f1_kernel_ph_out:
    s_add_u32 m0, s33, 0
    s_add_u32 s37, s24, 0
    buffer_load_dwordx4 v175, s[12:15], s37 offen sc0 sc1 lds
    s_add_u32 m0, s33, 1024
    s_add_u32 s37, s24, 16384
    buffer_load_dwordx4 v175, s[12:15], s37 offen sc0 sc1 lds
    s_add_u32 m0, s33, 2048
    s_add_u32 s37, s24, 32768
    buffer_load_dwordx4 v175, s[12:15], s37 offen sc0 sc1 lds
    s_add_u32 m0, s33, 3072
    s_add_u32 s37, s24, 49152
    buffer_load_dwordx4 v175, s[12:15], s37 offen sc0 sc1 lds
    s_add_u32 s24, s24, 128
    s_add_u32 m0, s33, 16384
    s_add_u32 s37, s24, 0
    buffer_load_dwordx4 v175, s[12:15], s37 offen sc0 sc1 lds
    s_add_u32 m0, s33, 17408
    s_add_u32 s37, s24, 16384
    buffer_load_dwordx4 v175, s[12:15], s37 offen sc0 sc1 lds
    s_add_u32 m0, s33, 18432
    s_add_u32 s37, s24, 32768
    buffer_load_dwordx4 v175, s[12:15], s37 offen sc0 sc1 lds
    s_add_u32 m0, s33, 19456
    s_add_u32 s37, s24, 49152
    buffer_load_dwordx4 v175, s[12:15], s37 offen sc0 sc1 lds
    s_add_u32 s24, s24, 128
    s_add_u32 m0, s81, 57344
    s_nop 0
    buffer_load_dwordx4 v168, s[8:11], s80 offen lds
    s_add_u32 m0, s81, 58368
    s_nop 0
    buffer_load_dwordx4 v169, s[8:11], s80 offen lds
    s_add_u32 m0, s81, 59392
    s_nop 0
    buffer_load_dwordx4 v170, s[8:11], s80 offen lds
    s_add_u32 m0, s81, 60416
    s_nop 0
    buffer_load_dwordx4 v171, s[8:11], s80 offen lds
    s_add_u32 m0, s81, 61440
    s_nop 0
    buffer_load_dwordx4 v172, s[8:11], s80 offen lds
    s_add_u32 m0, s81, 62464
    s_nop 0
    buffer_load_dwordx4 v173, s[8:11], s80 offen lds
    s_add_u32 m0, s81, 63488
    s_nop 0
    buffer_load_dwordx4 v174, s[8:11], s80 offen lds
    s_add_u32 s80, s80, 458752
    s_add_u32 m0, s33, 32768
    s_add_u32 s37, s24, 0
    buffer_load_dwordx4 v175, s[12:15], s37 offen sc0 sc1 lds
    s_add_u32 m0, s33, 33792
    s_add_u32 s37, s24, 16384
    buffer_load_dwordx4 v175, s[12:15], s37 offen sc0 sc1 lds
    s_add_u32 m0, s33, 34816
    s_add_u32 s37, s24, 32768
    buffer_load_dwordx4 v175, s[12:15], s37 offen sc0 sc1 lds
    s_add_u32 m0, s33, 35840
    s_add_u32 s37, s24, 49152
    buffer_load_dwordx4 v175, s[12:15], s37 offen sc0 sc1 lds
    s_add_u32 s24, s24, 128
    s_waitcnt vmcnt(15)
    s_barrier
    s_mov_b32 s26, 0
    s_mov_b32 s25, 0
    s_mov_b32 s23, 13
    s_waitcnt vmcnt(11)
    s_branch f1_kernel_g1l2
f1_kernel_g1l:
    s_waitcnt vmcnt(11)
f1_kernel_g1l2:
    s_barrier
    s_add_u32 s35, s26, s81
    s_add_u32 s36, s25, s33
    s_add_u32 m0, s35, 0
    s_nop 0
    buffer_load_dwordx4 v168, s[8:11], s80 offen lds
    s_add_u32 m0, s35, 1024
    s_nop 0
    buffer_load_dwordx4 v169, s[8:11], s80 offen lds
    s_add_u32 m0, s35, 2048
    s_nop 0
    buffer_load_dwordx4 v170, s[8:11], s80 offen lds
    s_add_u32 m0, s35, 3072
    s_nop 0
    buffer_load_dwordx4 v171, s[8:11], s80 offen lds
    s_add_u32 m0, s35, 4096
    s_nop 0
    buffer_load_dwordx4 v172, s[8:11], s80 offen lds
    s_add_u32 m0, s35, 5120
    s_nop 0
    buffer_load_dwordx4 v173, s[8:11], s80 offen lds
    s_add_u32 m0, s35, 6144
    s_nop 0
    buffer_load_dwordx4 v174, s[8:11], s80 offen lds
    s_add_u32 s80, s80, 458752
    s_add_u32 m0, s36, 0
    s_add_u32 s37, s24, 0
    buffer_load_dwordx4 v175, s[12:15], s37 offen sc0 sc1 lds
    s_add_u32 m0, s36, 1024
    s_add_u32 s37, s24, 16384
    buffer_load_dwordx4 v175, s[12:15], s37 offen sc0 sc1 lds
    s_add_u32 m0, s36, 2048
    s_add_u32 s37, s24, 32768
    buffer_load_dwordx4 v175, s[12:15], s37 offen sc0 sc1 lds
    s_add_u32 m0, s36, 3072
    s_add_u32 s37, s24, 49152
    buffer_load_dwordx4 v175, s[12:15], s37 offen sc0 sc1 lds
    s_add_u32 s24, s24, 128
    s_cmp_le_u32 s23, 4
    s_cbranch_scc1 f1_kernel_t1
    s_load_dword s44, s[38:39], 0
    s_load_dword s45, s[38:39], 64
    s_load_dword s46, s[38:39], 128
    s_load_dword s47, s[38:39], 192
    s_load_dword s44, s[38:39], 256
    s_load_dword s45, s[38:39], 320
    s_load_dword s46, s[38:39], 384
    s_add_u32 s38, s38, 458752
    s_addc_u32 s39, s39, 0
f1_kernel_t1:
    s_cmp_gt_u32 s23, 8
    s_cbranch_scc1 f1_kernel_t2
    s_sub_u32 s53, s82, 6
    s_cmp_ge_i32 s53, s61
    s_cselect_b32 s53, s82, s53
    s_add_u32 s62, s82, s61
    s_cmp_lt_u32 s82, 6
    s_cselect_b32 s62, s62, s53
    s_lshl_b32 s62, s62, 16
    s_load_dword s44, s[54:55], s62
    s_add_u32 s62, s62, 64
    s_load_dword s45, s[54:55], s62
    s_add_u32 s62, s62, 64
    s_load_dword s46, s[54:55], s62
    s_add_u32 s62, s62, 64
    s_load_dword s47, s[54:55], s62
    s_add_u32 s82, s82, 2
f1_kernel_t2:
    s_add_u32 s26, s26, 28672
    s_add_u32 s25, s25, 16384
    s_cmp_eq_u32 s25, 49152
    s_cselect_b32 s26, 0, s26
    s_cselect_b32 s25, 0, s25
    s_sub_u32 s23, s23, 1
    s_cmp_lg_u32 s23, 0
    s_cbranch_scc1 f1_kernel_g1l
    s_waitcnt lgkmcnt(0)
    s_getpc_b64 s[46:47]
f1_kernel_ct3:
    s_sub_u32 s46, s46, f1_kernel_ct3-f1_kernel
    s_subb_u32 s47, s47, 0
    s_lshr_b32 s44, s2, 3
    s_lshl_b32 s44, s44, 2
    s_add_u32 s44, s44, s63
    s_mul_i32 s44, s44, 320
    s_min_u32 s44, s44, code_end-f1_kernel-320
    s_add_u32 s46, s46, s44
    s_addc_u32 s47, s47, 0
    s_load_dword s45, s[46:47], 0
    s_load_dword s45, s[46:47], 64
    s_load_dword s45, s[46:47], 128
    s_load_dword s45, s[46:47], 192
    s_load_dword s45, s[46:47], 256
    s_lshr_b32 s52, s22, 3
    s_and_b32 s22, s22, 7
    v_lshrrev_b32 v4, 4, v2
    v_lshlrev_b32 v5, 1, v4
    v_and_b32 v6, 15, v2
    v_xor_b32 v5, v5, v6
    v_lshlrev_b32 v5, 4, v5
    v_lshl_add_u32 v5, v4, 11, v5
    v_xor_b32 v6, 128, v5
    s_lshl_b32 s24, s21, 3
    s_lshl_b32 s27, s63, 1
    s_add_u32 s24, s24, s27
    s_mul_i32 s24, s24, 114688
    s_mul_i32 s27, s52, 57344
    s_add_u32 s24, s24, s27
    s_lshl_b32 s80, s22, 8
    s_and_b32 s27, s63, 1
    s_lshl_b32 s27, s27, 15
    s_add_u32 s80, s80, s27
    s_mul_i32 s27, s52, 3670016
    s_add_u32 s80, s80, s27
    s_lshr_b32 s28, s63, 1
    s_mov_b32 s29, 6
    s_lshl_b32 s81, s63, 12
    s_add_u32 s33, s81, 65536
    s_lshl_b32 s27, s21, 4
    s_lshl_b32 s30, s52, 3
    s_add_u32 s27, s27, s30
    v_and_b32 v7, 7, v2
    v_add_u32 v7, s27, v7
    v_lshlrev_b32 v7, 10, v7
    v_add_u32 v7, 640, v7
    s_waitcnt vmcnt(11)
    s_barrier
    s_waitcnt vmcnt(0)
    s_barrier
    s_waitcnt vmcnt(0)
    s_barrier
    s_mov_b32 s8, s72
    s_mov_b32 s9, s73
    s_mov_b32 s10, 0x700000
    s_mov_b32 s11, 0x20000
    s_add_u32 s12, s4, 0x1000000
    s_addc_u32 s13, s5, 0
    s_mov_b32 s14, 0xe00000
    s_mov_b32 s15, 0x20000
    s_sub_u32 s31, s28, 6
    s_cmp_ge_i32 s31, s61
    s_cselect_b32 s31, s28, s31
    s_add_u32 s30, s28, s61
    s_cmp_lt_u32 s28, 6
    s_cselect_b32 s30, s30, s31
    s_lshl_b32 s30, s30, 16
    s_add_u32 s30, s30, s80
    s_add_u32 m0, s81, 0
    s_add_u32 s37, s30, 0
    buffer_load_dwordx4 v5, s[8:11], s37 offen lds
    s_add_u32 m0, s81, 1024
    s_add_u32 s37, s30, 8192
    buffer_load_dwordx4 v5, s[8:11], s37 offen lds
    s_add_u32 m0, s81, 2048
    s_add_u32 s37, s30, 16384
    buffer_load_dwordx4 v6, s[8:11], s37 offen lds
    s_add_u32 m0, s81, 3072
    s_add_u32 s37, s30, 24576
    buffer_load_dwordx4 v6, s[8:11], s37 offen lds
    s_add_u32 s28, s28, 2
    s_sub_u32 s31, s28, 6
    s_cmp_ge_i32 s31, s61
    s_cselect_b32 s31, s28, s31
    s_add_u32 s30, s28, s61
    s_cmp_lt_u32 s28, 6
    s_cselect_b32 s30, s30, s31
    s_lshl_b32 s30, s30, 16
    s_add_u32 s30, s30, s80
    s_add_u32 m0, s81, 16384
    s_add_u32 s37, s30, 0
    buffer_load_dwordx4 v5, s[8:11], s37 offen lds
    s_add_u32 m0, s81, 17408
    s_add_u32 s37, s30, 8192
    buffer_load_dwordx4 v5, s[8:11], s37 offen lds
    s_add_u32 m0, s81, 18432
    s_add_u32 s37, s30, 16384
    buffer_load_dwordx4 v6, s[8:11], s37 offen lds
    s_add_u32 m0, s81, 19456
    s_add_u32 s37, s30, 24576
    buffer_load_dwordx4 v6, s[8:11], s37 offen lds
    s_add_u32 s28, s28, 2
    s_sub_u32 s31, s28, 6
    s_cmp_ge_i32 s31, s61
    s_cselect_b32 s31, s28, s31
    s_add_u32 s30, s28, s61
    s_cmp_lt_u32 s28, 6
    s_cselect_b32 s30, s30, s31
    s_lshl_b32 s30, s30, 16
    s_add_u32 s30, s30, s80
    s_add_u32 m0, s81, 32768
    s_add_u32 s37, s30, 0
    buffer_load_dwordx4 v5, s[8:11], s37 offen lds
    s_add_u32 m0, s81, 33792
    s_add_u32 s37, s30, 8192
    buffer_load_dwordx4 v5, s[8:11], s37 offen lds
    s_add_u32 m0, s81, 34816
    s_add_u32 s37, s30, 16384
    buffer_load_dwordx4 v6, s[8:11], s37 offen lds
    s_add_u32 m0, s81, 35840
    s_add_u32 s37, s30, 24576
    buffer_load_dwordx4 v6, s[8:11], s37 offen lds
    s_add_u32 s28, s28, 2
    s_sub_u32 s31, s28, 6
    s_cmp_ge_i32 s31, s61
    s_cselect_b32 s31, s28, s31
    s_add_u32 s30, s28, s61
    s_cmp_lt_u32 s28, 6
    s_cselect_b32 s30, s30, s31
    s_lshl_b32 s30, s30, 16
    s_add_u32 s30, s30, s80
    s_add_u32 m0, s81, 49152
    s_add_u32 s37, s30, 0
    buffer_load_dwordx4 v5, s[8:11], s37 offen lds
    s_add_u32 m0, s81, 50176
    s_add_u32 s37, s30, 8192
    buffer_load_dwordx4 v5, s[8:11], s37 offen lds
    s_add_u32 m0, s81, 51200
    s_add_u32 s37, s30, 16384
    buffer_load_dwordx4 v6, s[8:11], s37 offen lds
    s_add_u32 m0, s81, 52224
    s_add_u32 s37, s30, 24576
    buffer_load_dwordx4 v6, s[8:11], s37 offen lds
    s_add_u32 s28, s28, 2
    v_and_b32 v8, 1, v2
    v_lshlrev_b32 v8, 10, v8
    v_readfirstlane_b32 s27, v7
    s_nop 1
    v_add_u32 v8, s27, v8
    s_waitcnt vmcnt(12)
    s_barrier
    s_waitcnt vmcnt(8)
    s_barrier
    s_waitcnt vmcnt(4)
    s_barrier
    s_mov_b32 s60, 0x40000
    s_branch f1_kernel_pa0_in
f1_kernel_pa0:
    s_sleep 1
f1_kernel_pa0_in:
    buffer_load_dword v15, v8, s[56:59], 0 offen sc0 sc1
    s_sub_u32 s60, s60, 1
    s_cmp_eq_u32 s60, 0
    s_cbranch_scc1 f1_kernel_pa0_out
    s_waitcnt vmcnt(0)
    v_cmp_ne_u32 vcc, s83, v15
    s_nop 1
    s_cbranch_vccnz f1_kernel_pa0
f1_kernel_pa0_out:
    s_add_u32 m0, s33, 49152
    s_sub_u32 s31, s29, 6
    s_cmp_ge_u32 s31, s61
    s_cselect_b32 s30, s29, s31
    s_lshl_b32 s30, s30, 10
    s_add_u32 s30, s30, s24
    s_add_u32 s37, s30, 114688
    buffer_load_dwordx4 v3, s[12:15], s30 offen sc0 sc1 lds
    s_add_u32 m0, m0, 2048
    s_add_u32 s29, s29, 1
    buffer_load_dwordx4 v3, s[12:15], s37 offen sc0 sc1 lds
    s_sub_u32 m0, m0, 1024
    s_sub_u32 s31, s29, 6
    s_cmp_ge_u32 s31, s61
    s_cselect_b32 s30, s29, s31
    s_lshl_b32 s30, s30, 10
    s_add_u32 s30, s30, s24
    s_add_u32 s37, s30, 114688
    buffer_load_dwordx4 v3, s[12:15], s30 offen sc0 sc1 lds
    s_add_u32 m0, m0, 2048
    s_add_u32 s29, s29, 1
    buffer_load_dwordx4 v3, s[12:15], s37 offen sc0 sc1 lds
    s_mov_b32 s26, 0
    s_add_u32 s35, s26, s81
    s_sub_u32 s31, s28, 6
    s_cmp_ge_i32 s31, s61
    s_cselect_b32 s31, s28, s31
    s_add_u32 s30, s28, s61
    s_cmp_lt_u32 s28, 6
    s_cselect_b32 s30, s30, s31
    s_lshl_b32 s30, s30, 16
    s_add_u32 s30, s30, s80
    s_add_u32 m0, s35, 0
    s_add_u32 s37, s30, 0
    buffer_load_dwordx4 v5, s[8:11], s37 offen lds
    s_add_u32 m0, s35, 1024
    s_add_u32 s37, s30, 8192
    buffer_load_dwordx4 v5, s[8:11], s37 offen lds
    s_add_u32 m0, s35, 2048
    s_add_u32 s37, s30, 16384
    buffer_load_dwordx4 v6, s[8:11], s37 offen lds
    s_add_u32 m0, s35, 3072
    s_add_u32 s37, s30, 24576
    buffer_load_dwordx4 v6, s[8:11], s37 offen lds
    s_add_u32 s28, s28, 2
    s_add_u32 m0, s33, s26
    s_sub_u32 s31, s29, 6
    s_cmp_ge_u32 s31, s61
    s_cselect_b32 s30, s29, s31
    s_lshl_b32 s30, s30, 10
    s_add_u32 s30, s30, s24
    s_add_u32 s37, s30, 114688
    buffer_load_dwordx4 v3, s[12:15], s30 offen sc0 sc1 lds
    s_add_u32 m0, m0, 2048
    s_add_u32 s29, s29, 1
    buffer_load_dwordx4 v3, s[12:15], s37 offen sc0 sc1 lds
    s_sub_u32 m0, m0, 1024
    s_sub_u32 s31, s29, 6
    s_cmp_ge_u32 s31, s61
    s_cselect_b32 s30, s29, s31
    s_lshl_b32 s30, s30, 10
    s_add_u32 s30, s30, s24
    s_add_u32 s37, s30, 114688
    buffer_load_dwordx4 v3, s[12:15], s30 offen sc0 sc1 lds
    s_add_u32 m0, m0, 2048
    s_add_u32 s29, s29, 1
    buffer_load_dwordx4 v3, s[12:15], s37 offen sc0 sc1 lds
    s_sub_u32 s53, s82, 6
    s_cmp_ge_i32 s53, s61
    s_cselect_b32 s53, s82, s53
    s_add_u32 s62, s82, s61
    s_cmp_lt_u32 s82, 6
    s_cselect_b32 s62, s62, s53
    s_lshl_b32 s62, s62, 16
    s_load_dword s44, s[54:55], s62
    s_add_u32 s62, s62, 64
    s_load_dword s45, s[54:55], s62
    s_add_u32 s62, s62, 64
    s_load_dword s46, s[54:55], s62
    s_add_u32 s62, s62, 64
    s_load_dword s47, s[54:55], s62
    s_add_u32 s82, s82, 2
    s_add_u32 s26, s26, 16384
    s_and_b32 s26, s26, 0xffff
    s_add_u32 s35, s26, s81
    s_sub_u32 s31, s28, 6
    s_cmp_ge_i32 s31, s61
    s_cselect_b32 s31, s28, s31
    s_add_u32 s30, s28, s61
    s_cmp_lt_u32 s28, 6
    s_cselect_b32 s30, s30, s31
    s_lshl_b32 s30, s30, 16
    s_add_u32 s30, s30, s80
    s_add_u32 m0, s35, 0
    s_add_u32 s37, s30, 0
    buffer_load_dwordx4 v5, s[8:11], s37 offen lds
    s_add_u32 m0, s35, 1024
    s_add_u32 s37, s30, 8192
    buffer_load_dwordx4 v5, s[8:11], s37 offen lds
    s_add_u32 m0, s35, 2048
    s_add_u32 s37, s30, 16384
    buffer_load_dwordx4 v6, s[8:11], s37 offen lds
    s_add_u32 m0, s35, 3072
    s_add_u32 s37, s30, 24576
    buffer_load_dwordx4 v6, s[8:11], s37 offen lds
    s_add_u32 s28, s28, 2
    s_add_u32 m0, s33, s26
    s_sub_u32 s31, s29, 6
    s_cmp_ge_u32 s31, s61
    s_cselect_b32 s30, s29, s31
    s_lshl_b32 s30, s30, 10
    s_add_u32 s30, s30, s24
    s_add_u32 s37, s30, 114688
    buffer_load_dwordx4 v3, s[12:15], s30 offen sc0 sc1 lds
    s_add_u32 m0, m0, 2048
    s_add_u32 s29, s29, 1
    buffer_load_dwordx4 v3, s[12:15], s37 offen sc0 sc1 lds
    s_sub_u32 m0, m0, 1024
    s_sub_u32 s31, s29, 6
    s_cmp_ge_u32 s31, s61
    s_cselect_b32 s30, s29, s31
    s_lshl_b32 s30, s30, 10
    s_add_u32 s30, s30, s24
    s_add_u32 s37, s30, 114688
    buffer_load_dwordx4 v3, s[12:15], s30 offen sc0 sc1 lds
    s_add_u32 m0, m0, 2048
    s_add_u32 s29, s29, 1
    buffer_load_dwordx4 v3, s[12:15], s37 offen sc0 sc1 lds
    s_sub_u32 s53, s82, 6
    s_cmp_ge_i32 s53, s61
    s_cselect_b32 s53, s82, s53
    s_add_u32 s62, s82, s61
    s_cmp_lt_u32 s82, 6
    s_cselect_b32 s62, s62, s53
    s_lshl_b32 s62, s62, 16
    s_load_dword s44, s[54:55], s62
    s_add_u32 s62, s62, 64
    s_load_dword s45, s[54:55], s62
    s_add_u32 s62, s62, 64
    s_load_dword s46, s[54:55], s62
    s_add_u32 s62, s62, 64
    s_load_dword s47, s[54:55], s62
    s_add_u32 s82, s82, 2
    s_add_u32 s26, s26, 16384
    s_and_b32 s26, s26, 0xffff
    s_waitcnt vmcnt(16)
    s_barrier
    s_mov_b32 s60, 0x40000
    s_branch f1_kernel_pa_in
f1_kernel_pa:
    s_sleep 1
f1_kernel_pa_in:
    buffer_load_dword v15, v7, s[56:59], 0 offen sc0 sc1
    s_sub_u32 s60, s60, 1
    s_cmp_eq_u32 s60, 0
    s_cbranch_scc1 f1_kernel_pa_out
    s_waitcnt vmcnt(0)
    v_cmp_ne_u32 vcc, s83, v15
    s_nop 1
    s_cbranch_vccnz f1_kernel_pa
f1_kernel_pa_out:
    s_add_u32 s35, s26, s81
    s_sub_u32 s31, s28, 6
    s_cmp_ge_i32 s31, s61
    s_cselect_b32 s31, s28, s31
    s_add_u32 s30, s28, s61
    s_cmp_lt_u32 s28, 6
    s_cselect_b32 s30, s30, s31
    s_lshl_b32 s30, s30, 16
    s_add_u32 s30, s30, s80
    s_add_u32 m0, s35, 0
    s_add_u32 s37, s30, 0
    buffer_load_dwordx4 v5, s[8:11], s37 offen lds
    s_add_u32 m0, s35, 1024
    s_add_u32 s37, s30, 8192
    buffer_load_dwordx4 v5, s[8:11], s37 offen lds
    s_add_u32 m0, s35, 2048
    s_add_u32 s37, s30, 16384
    buffer_load_dwordx4 v6, s[8:11], s37 offen lds
    s_add_u32 m0, s35, 3072
    s_add_u32 s37, s30, 24576
    buffer_load_dwordx4 v6, s[8:11], s37 offen lds
    s_add_u32 s28, s28, 2
    s_add_u32 m0, s33, s26
    s_sub_u32 s31, s29, 6
    s_cmp_ge_u32 s31, s61
    s_cselect_b32 s30, s29, s31
    s_lshl_b32 s30, s30, 10
    s_add_u32 s30, s30, s24
    s_add_u32 s37, s30, 114688
    buffer_load_dwordx4 v3, s[12:15], s30 offen sc0 sc1 lds
    s_add_u32 m0, m0, 2048
    s_add_u32 s29, s29, 1
    buffer_load_dwordx4 v3, s[12:15], s37 offen sc0 sc1 lds
    s_sub_u32 m0, m0, 1024
    s_sub_u32 s31, s29, 6
    s_cmp_ge_u32 s31, s61
    s_cselect_b32 s30, s29, s31
    s_lshl_b32 s30, s30, 10
    s_add_u32 s30, s30, s24
    s_add_u32 s37, s30, 114688
    buffer_load_dwordx4 v3, s[12:15], s30 offen sc0 sc1 lds
    s_add_u32 m0, m0, 2048
    s_add_u32 s29, s29, 1
    buffer_load_dwordx4 v3, s[12:15], s37 offen sc0 sc1 lds
    s_sub_u32 s53, s82, 6
    s_cmp_ge_i32 s53, s61
    s_cselect_b32 s53, s82, s53
    s_add_u32 s62, s82, s61
    s_cmp_lt_u32 s82, 6
    s_cselect_b32 s62, s62, s53
    s_lshl_b32 s62, s62, 16
    s_load_dword s44, s[54:55], s62
    s_add_u32 s62, s62, 64
    s_load_dword s45, s[54:55], s62
    s_add_u32 s62, s62, 64
    s_load_dword s46, s[54:55], s62
    s_add_u32 s62, s62, 64
    s_load_dword s47, s[54:55], s62
    s_add_u32 s82, s82, 2
    s_add_u32 s26, s26, 16384
    s_and_b32 s26, s26, 0xffff
    s_mov_b32 s23, 17
f1_kernel_g2l:
    s_waitcnt vmcnt(16)
    s_barrier
    s_add_u32 s35, s26, s81
    s_sub_u32 s31, s28, 6
    s_cmp_ge_i32 s31, s61
    s_cselect_b32 s31, s28, s31
    s_add_u32 s30, s28, s61
    s_cmp_lt_u32 s28, 6
    s_cselect_b32 s30, s30, s31
    s_lshl_b32 s30, s30, 16
    s_add_u32 s30, s30, s80
    s_add_u32 m0, s35, 0
    s_add_u32 s37, s30, 0
    buffer_load_dwordx4 v5, s[8:11], s37 offen lds
    s_add_u32 m0, s35, 1024
    s_add_u32 s37, s30, 8192
    buffer_load_dwordx4 v5, s[8:11], s37 offen lds
    s_add_u32 m0, s35, 2048
    s_add_u32 s37, s30, 16384
    buffer_load_dwordx4 v6, s[8:11], s37 offen lds
    s_add_u32 m0, s35, 3072
    s_add_u32 s37, s30, 24576
    buffer_load_dwordx4 v6, s[8:11], s37 offen lds
    s_add_u32 s28, s28, 2
    s_add_u32 m0, s33, s26
    s_sub_u32 s31, s29, 6
    s_cmp_ge_u32 s31, s61
    s_cselect_b32 s30, s29, s31
    s_lshl_b32 s30, s30, 10
    s_add_u32 s30, s30, s24
    s_add_u32 s37, s30, 114688
    buffer_load_dwordx4 v3, s[12:15], s30 offen sc0 sc1 lds
    s_add_u32 m0, m0, 2048
    s_add_u32 s29, s29, 1
    buffer_load_dwordx4 v3, s[12:15], s37 offen sc0 sc1 lds
    s_sub_u32 m0, m0, 1024
    s_sub_u32 s31, s29, 6
    s_cmp_ge_u32 s31, s61
    s_cselect_b32 s30, s29, s31
    s_lshl_b32 s30, s30, 10
    s_add_u32 s30, s30, s24
    s_add_u32 s37, s30, 114688
    buffer_load_dwordx4 v3, s[12:15], s30 offen sc0 sc1 lds
    s_add_u32 m0, m0, 2048
    s_add_u32 s29, s29, 1
    buffer_load_dwordx4 v3, s[12:15], s37 offen sc0 sc1 lds
    s_sub_u32 s53, s82, 6
    s_cmp_ge_i32 s53, s61
    s_cselect_b32 s53, s82, s53
    s_add_u32 s62, s82, s61
    s_cmp_lt_u32 s82, 6
    s_cselect_b32 s62, s62, s53
    s_lshl_b32 s62, s62, 16
    s_load_dword s44, s[54:55], s62
    s_add_u32 s62, s62, 64
    s_load_dword s45, s[54:55], s62
    s_add_u32 s62, s62, 64
    s_load_dword s46, s[54:55], s62
    s_add_u32 s62, s62, 64
    s_load_dword s47, s[54:55], s62
    s_add_u32 s82, s82, 2
    s_add_u32 s26, s26, 16384
    s_and_b32 s26, s26, 0xffff
    s_sub_u32 s23, s23, 1
    s_cmp_lg_u32 s23, 0
    s_cbranch_scc1 f1_kernel_g2l
    s_mov_b32 s23, 4
f1_kernel_g2m:
    s_waitcnt vmcnt(16)
    s_barrier
    s_add_u32 s35, s26, s81
    s_sub_u32 s31, s28, 6
    s_cmp_ge_i32 s31, s61
    s_cselect_b32 s31, s28, s31
    s_add_u32 s30, s28, s61
    s_cmp_lt_u32 s28, 6
    s_cselect_b32 s30, s30, s31
    s_lshl_b32 s30, s30, 16
    s_add_u32 s30, s30, s80
    s_add_u32 m0, s35, 0
    s_add_u32 s37, s30, 0
    buffer_load_dwordx4 v5, s[8:11], s37 offen lds
    s_add_u32 m0, s35, 1024
    s_add_u32 s37, s30, 8192
    buffer_load_dwordx4 v5, s[8:11], s37 offen lds
    s_add_u32 m0, s35, 2048
    s_add_u32 s37, s30, 16384
    buffer_load_dwordx4 v6, s[8:11], s37 offen lds
    s_add_u32 m0, s35, 3072
    s_add_u32 s37, s30, 24576
    buffer_load_dwordx4 v6, s[8:11], s37 offen lds
    s_add_u32 s28, s28, 2
    s_add_u32 m0, s33, s26
    s_sub_u32 s31, s29, 6
    s_cmp_ge_u32 s31, s61
    s_cselect_b32 s30, s29, s31
    s_lshl_b32 s30, s30, 10
    s_add_u32 s30, s30, s24
    s_add_u32 s37, s30, 114688
    buffer_load_dwordx4 v3, s[12:15], s30 offen sc0 sc1 lds
    s_add_u32 m0, m0, 2048
    s_add_u32 s29, s29, 1
    buffer_load_dwordx4 v3, s[12:15], s37 offen sc0 sc1 lds
    s_sub_u32 m0, m0, 1024
    s_sub_u32 s31, s29, 6
    s_cmp_ge_u32 s31, s61
    s_cselect_b32 s30, s29, s31
    s_lshl_b32 s30, s30, 10
    s_add_u32 s30, s30, s24
    s_add_u32 s37, s30, 114688
    buffer_load_dwordx4 v3, s[12:15], s30 offen sc0 sc1 lds
    s_add_u32 m0, m0, 2048
    s_add_u32 s29, s29, 1
    buffer_load_dwordx4 v3, s[12:15], s37 offen sc0 sc1 lds
    s_add_u32 s26, s26, 16384
    s_and_b32 s26, s26, 0xffff
    s_sub_u32 s23, s23, 1
    s_cmp_lg_u32 s23, 0
    s_cbranch_scc1 f1_kernel_g2m
    s_waitcnt lgkmcnt(0)
    s_getpc_b64 s[46:47]
f1_kernel_ct4:
    s_sub_u32 s46, s46, f1_kernel_ct4-f1_kernel
    s_subb_u32 s47, s47, 0
    s_lshr_b32 s44, s2, 3
    s_lshl_b32 s44, s44, 2
    s_add_u32 s44, s44, s63
    s_mul_i32 s44, s44, 320
    s_min_u32 s44, s44, code_end-f1_kernel-320
    s_add_u32 s46, s46, s44
    s_addc_u32 s47, s47, 0
    s_load_dword s45, s[46:47], 0
    s_load_dword s45, s[46:47], 64
    s_load_dword s45, s[46:47], 128
    s_load_dword s45, s[46:47], 192
    s_load_dword s45, s[46:47], 256
    s_waitcnt vmcnt(16)
    s_barrier
    s_waitcnt vmcnt(8)
    s_barrier
    s_waitcnt vmcnt(0)
    s_barrier
    s_waitcnt vmcnt(0)
    s_barrier
f1_kernel_done:
    s_endpgm
.section .rodata,"a"
.p2align 6
.amdhsa_kernel f1_kernel
  .amdhsa_next_free_vgpr 240
  .amdhsa_next_free_sgpr 102
  .amdhsa_accum_offset 240
  .amdhsa_group_segment_fixed_size 0
  .amdhsa_kernarg_size 112
  .amdhsa_user_sgpr_count 2
  .amdhsa_user_sgpr_kernarg_segment_ptr 1
  .amdhsa_system_sgpr_workgroup_id_x 1
  .amdhsa_float_denorm_mode_32 3
  .amdhsa_float_denorm_mode_16_64 3
.end_amdhsa_kernel
.text
code_end:
    s_endpgm
```
